```python
import torch

def _softmax(x, axis=-1):
    return torch.softmax(x, dim=axis)
def _gelu(x):
    return torch.nn.functional.gelu(x, approximate="tanh")
def _silu(x):
    return torch.nn.functional.silu(x)
def _sigmoid(x):
    return torch.sigmoid(x)
def _layernorm(x, axis=-1, eps=1e-5):
    m = x.mean(dim=axis, keepdim=True)
    v = x.var(dim=axis, keepdim=True, unbiased=False)
    return (x - m) / torch.sqrt(v + eps)
def _scatter_add(tgt, idx, src, axis=0):
    return tgt.clone().index_add_(axis, idx, src)
def _segment_sum(src, seg, n):
    out = torch.zeros((n,) + src.shape[1:], dtype=src.dtype)
    return out.index_add_(0, seg, src)
def _pad(x, pw):
    flat = tuple(v for pair in reversed(pw) for v in pair)
    return torch.nn.functional.pad(x, flat)

kernel_name = 'parallel_sum__ssm_conv_h3__mixer_s_mlp__prompt'

def setup_inputs():

    _w = (lambda a: (lambda t: t.to(torch.bfloat16) if t.is_floating_point() else t)(torch.as_tensor(a)))
    def _A_setup():
        B, S, D = 1, 2048, 640
        ks = 4
        return {
            "q": _w((lambda *s: torch.randn(*s, dtype=torch.bfloat16) * 0.05)(B, S, D)),
            "k": _w((lambda *s: torch.randn(*s, dtype=torch.bfloat16) * 0.8)(B, S, D)),
            "v": _w((lambda *s: torch.randn(*s, dtype=torch.bfloat16) * 0.8)(B, S, D)),
            "shift_k": _w((lambda *s: torch.randn(*s, dtype=torch.bfloat16) * 0.8)(D, ks) * 0.5),
            "ssm_k": _w((lambda *s: torch.randn(*s, dtype=torch.bfloat16) * 1.6)(D, S) * (1.0 / S ** 0.5)),
            "ssm_D": _w((lambda *s: torch.randn(*s, dtype=torch.bfloat16) * 0.8)(D)),
        }
    _A_in = _A_setup()

    def _B_setup():
        B, S, D, F = 1, 2048, 640, 1536
        return {
            "x":  _w((lambda *s: torch.randn(*s, dtype=torch.bfloat16) * 0.05)(B, S, D)),
            "w1": _w((lambda *s: torch.randn(*s, dtype=torch.bfloat16) * 3.2)(D, D) * (D ** -0.5)),
            "w2": _w((lambda *s: torch.randn(*s, dtype=torch.bfloat16) * 3.2)(D, D) * (D ** -0.5)),
            "w3": _w((lambda *s: torch.randn(*s, dtype=torch.bfloat16) * 3.2)(D, F) * (D ** -0.5)),
            "w4": _w((lambda *s: torch.randn(*s, dtype=torch.bfloat16) * 3.2)(F, D) * (F ** -0.5)),
        }
    _B_in = _B_setup()

    return {
        "A_q": _A_in["q"],
        "A_k": _A_in["k"],
        "A_v": _A_in["v"],
        "A_shift_k": _A_in["shift_k"],
        "A_ssm_k": _A_in["ssm_k"],
        "A_ssm_D": _A_in["ssm_D"],
        "B_x": _B_in["x"],
        "B_w1": _B_in["w1"],
        "B_w2": _B_in["w2"],
        "B_w3": _B_in["w3"],
        "B_w4": _B_in["w4"],
    }

def reference(A_q, A_k, A_v, A_shift_k, A_ssm_k, A_ssm_D, B_x, B_w1, B_w2, B_w3, B_w4):
    def _A_ref(q, k, v, shift_k, ssm_k, ssm_D):
        B, S, D = q.shape
        ks = shift_k.shape[-1]
        k_pad = _pad(k, ((0, 0), (ks - 1, 0), (0, 0)))
        k_shift = torch.zeros_like(k)
        for t in range(ks):
            k_shift = k_shift + k_pad[:, t:t + S, :] * shift_k[:, ks - 1 - t][None, None, :]
        kv = k_shift * v
        L = 2 * S
        kv_pad = _pad(kv, ((0, 0), (0, S), (0, 0)))
        kf_pad = _pad(ssm_k, ((0, 0), (0, S)))
        kv_f = (lambda x, axes=(-2,-1): torch.fft.rfft2(x.float(), dim=axes))(kv_pad[:, None, :, :], axes=(1, 2))
        kf_f = (lambda x, axes=(-2,-1): torch.fft.rfft2(x.float(), dim=axes))(kf_pad[:, None, :], axes=(1, 2))
        kf_f = (lambda x, *d: x.permute(*d))(kf_f, 1, 2, 0)
        y_f = kv_f * kf_f[None, :, :, :]
        y = (lambda x, s, axes=(-2,-1): torch.fft.irfft2(x, s=s, dim=axes).to(torch.bfloat16))(y_f, (1, L), axes=(1, 2))[:, 0, :S, :]
        y = y + kv * ssm_D[None, None, :]
        return q * y

    def _B_ref(x, w1, w2, w3, w4):
        B, S, D = x.shape
        h = _gelu(_layernorm(x, axis=-1) @ w1)
        c = D // 4
        g0 = _pad(h[:, :, 0*c:1*c], ((0, 0), (1, 0), (0, 0)))[:, :S, :]
        g1 = _pad(h[:, :, 1*c:2*c], ((0, 0), (0, 1), (0, 0)))[:, 1:, :]
        g2 = _pad(h[:, :, 2*c:3*c], ((0, 0), (2, 0), (0, 0)))[:, :S, :]
        g3 = _pad(h[:, :, 3*c:   ], ((0, 0), (0, 2), (0, 0)))[:, 2:, :]
        hs = torch.concatenate([g0, g1, g2, g3], axis=-1) @ w2
        x1 = x + hs
        h2 = _gelu(_layernorm(x1, axis=-1) @ w3) @ w4
        return x1 + h2

    x = A_q
    xn = _layernorm(x, axis=-1)
    return x + _A_ref(xn, A_k, A_v, A_shift_k, A_ssm_k, A_ssm_D) + _B_ref(xn, B_w1, B_w2, B_w3, B_w4)
```

```asm
; @launch kernel=kA_kernel grid=(252,1,1) block=(512,1,1) lds=147712
; @launch kernel=kB_kernel grid=(256,1,1) block=(512,1,1) lds=163840
; @launch kernel=kC_kernel grid=(256,1,1) block=(512,1,1) lds=163840
; @launch kernel=kD_kernel grid=(256,1,1) block=(512,1,1) lds=163840
.amdgcn_target "amdgcn-amd-amdhsa--gfx950"
.text
.globl kA_kernel
.p2align 8
.type kA_kernel,@function
kA_kernel:
  v_lshrrev_b32 v1, 6, v0
  v_and_b32 v0, 63, v0
  v_readfirstlane_b32 s60, v1
  s_cmp_ge_u32 s2, 160
  s_cbranch_scc1 A_side
  s_load_dwordx2 s[4:5], s[0:1], 104
  s_load_dwordx2 s[6:7], s[0:1], 56
  s_load_dwordx2 s[32:33], s[0:1], 0
  s_and_b32 s36, s60, 3
  s_and_b32 s37, s2, 7
  s_lshr_b32 s38, s2, 3
  s_and_b32 s39, s38, 1
  s_lshl_b32 s37, s37, 1
  s_add_u32 s37, s37, s39
  s_lshr_b32 s38, s38, 1
  s_mul_i32 s40, s37, 128
  s_mul_i32 s41, s38, 64
  s_cmp_lt_u32 s60, 4
  s_cbranch_scc1 A_comp
  v_lshrrev_b32 v1, 3, v0
  s_mul_i32 s44, s36, 32
  s_add_u32 s44, s44, s40
  v_add_u32 v1, s44, v1
  v_mul_u32_u24 v1, 1280, v1
  v_lshrrev_b32 v2, 4, v0
  v_and_b32 v3, 7, v0
  v_xor_b32 v2, v2, v3
  v_lshlrev_b32 v2, 4, v2
  v_xor_b32 v3, 64, v2
  v_add_u32 v8, v1, v2
  v_add_u32 v9, v1, v3
  v_add_u32 v9, 10240, v9
  v_add_u32 v10, 20480, v8
  v_add_u32 v11, 20480, v9
  v_lshrrev_b32 v1, 3, v0
  v_and_b32 v2, 7, v0
  v_and_b32 v3, 2, v1
  v_xor_b32 v2, v2, v3
  s_lshl_b32 s44, s36, 4
  v_add_u32 v1, s44, v1
  v_mul_u32_u24 v1, 1280, v1
  v_lshl_add_u32 v1, v2, 4, v1
  s_lshl_b32 s44, s41, 1
  v_add_u32 v12, s44, v1
  v_add_u32 v13, 10240, v12
  s_mul_i32 s46, s36, 4096
  s_mul_i32 s47, s36, 2048
  s_add_u32 s47, s47, 16384
  s_mov_b32 s48, 0
  s_mov_b32 s49, 0
  s_mov_b32 s50, 0
  s_mov_b32 s52, 0
  s_waitcnt lgkmcnt(0)
  s_mov_b32 s8, s32
  s_mov_b32 s9, s33
  s_mov_b32 s10, 0x280000
  s_mov_b32 s11, 0x00020000
  s_mov_b32 s12, s6
  s_mov_b32 s13, s7
  s_mov_b32 s14, 0xc8000
  s_mov_b32 s15, 0x00020000
A_ll:
  s_add_u32 m0, s46, 0
  s_nop 0
  buffer_load_dwordx4 v8, s[8:11], s48 offen lds
  s_add_u32 m0, s46, 1024
  s_nop 0
  buffer_load_dwordx4 v9, s[8:11], s48 offen lds
  s_add_u32 m0, s46, 2048
  s_nop 0
  buffer_load_dwordx4 v10, s[8:11], s48 offen lds
  s_add_u32 m0, s46, 3072
  s_nop 0
  buffer_load_dwordx4 v11, s[8:11], s48 offen lds
  s_add_u32 m0, s47, 0
  s_nop 0
  buffer_load_dwordx4 v12, s[12:15], s49 offen lds
  s_add_u32 m0, s47, 1024
  s_nop 0
  buffer_load_dwordx4 v13, s[12:15], s49 offen lds
  s_add_u32 s52, s52, 1
  s_cmp_eq_u32 s52, 6
  s_cselect_b32 s52, 0, s52
  s_mov_b32 s53, 24576
  s_cselect_b32 s53, -122880, s53
  s_add_u32 s46, s46, s53
  s_add_u32 s47, s47, s53
  s_add_u32 s48, s48, 128
  s_add_u32 s49, s49, 81920
  s_add_u32 s50, s50, 1
  s_cmp_lt_u32 s50, 4
  s_cbranch_scc1 A_ll
  s_waitcnt vmcnt(18)
  s_barrier
  s_cmp_lt_u32 s50, 10
  s_cbranch_scc1 A_ll
  s_waitcnt vmcnt(12)
  s_barrier
  s_waitcnt vmcnt(6)
  s_barrier
  s_waitcnt vmcnt(0)
  s_barrier
  s_waitcnt vmcnt(0)
  s_barrier
  s_load_dwordx2 s[6:7], s[0:1], 64
  s_lshr_b32 s63, s2, 3
  s_lshl_b32 s63, s63, 2
  s_add_u32 s63, s63, s36
  v_lshlrev_b32 v1, 7, v0
  s_waitcnt lgkmcnt(0)
  s_lshl_b32 s63, s63, 13
  s_mov_b32 s12, s6
  s_mov_b32 s13, s7
  s_mov_b32 s14, 0xc8000
  s_mov_b32 s15, 0x00020000
  s_mov_b32 s62, 2
A_wpf:
  s_min_u32 s63, s63, 811008
  s_sub_u32 s62, s62, 1
  buffer_load_dword v2, v1, s[12:15], s63 offen sc1
  s_add_u32 s63, s63, 655360
  s_cmp_lg_u32 s62, 0
  s_cbranch_scc1 A_wpf
  s_waitcnt vmcnt(0) lgkmcnt(0)
  s_endpgm
A_comp:
  v_mov_b32 v194, v0
  s_mov_b32 s42, s36
  s_mov_b32 s43, 0
  v_and_b32 v144, 31, v194
  v_lshrrev_b32 v145, 5, v194
  s_mul_i32 s44, s42, 32
  s_add_u32 s44, s44, s40
  v_add_u32 v146, s44, v144
  s_lshl_b32 s45, s43, 6
  s_add_u32 s45, s45, s41
  v_lshl_add_u32 v147, v145, 5, s45
  v_mul_u32_u24 v190, 1280, v146
  v_lshl_add_u32 v190, v147, 1, v190
  v_lshlrev_b32 v191, 3, v146
  v_mul_u32_u24 v192, 80, v146
  s_waitcnt lgkmcnt(0)
  s_lshr_b32 s63, s2, 3
  s_lshl_b32 s63, s63, 2
  s_add_u32 s63, s63, s36
  s_and_b32 s44, s2, 7
  s_mul_i32 s46, s44, 327680
  v_mul_u32_u24 v196, 1280, v0
  v_lshlrev_b32 v197, 7, v0
  s_mov_b32 s8, s32
  s_mov_b32 s9, s33
  s_mov_b32 s10, 0x280000
  s_mov_b32 s11, 0x00020000
  s_mov_b32 s12, s6
  s_mov_b32 s13, s7
  s_mov_b32 s14, 0xc8000
  s_mov_b32 s15, 0x00020000
A_pfl:
  s_lshl_b32 s44, s63, 13
  buffer_load_dword v198, v197, s[12:15], s44 offen sc1
  s_cmp_ge_u32 s63, 40
  s_cbranch_scc1 A_pf2
  s_and_b32 s44, s63, 3
  s_mul_i32 s44, s44, 81920
  s_lshr_b32 s45, s63, 2
  s_lshl_b32 s45, s45, 7
  s_add_u32 s44, s44, s45
  s_add_u32 s44, s44, s46
  buffer_load_dword v198, v196, s[8:11], s44 offen sc1
A_pf2:
  s_add_u32 s63, s63, 80
  s_cmp_lt_u32 s63, 100
  s_cbranch_scc1 A_pfl
  s_mov_b32 s16, s4
  s_mov_b32 s17, s5
  s_mov_b32 s18, 0x281400
  s_mov_b32 s19, 0x00020000
  s_add_u32 s28, s4, 0x290000
  s_addc_u32 s29, s5, 0
  s_mov_b32 s30, 0x4000
  s_mov_b32 s31, 0x00020000
  v_lshrrev_b32 v140, 3, v194
  v_and_b32 v141, 7, v194
  v_xor_b32 v142, v140, v141
  s_mul_i32 s44, s42, 32
  s_add_u32 s44, s44, s40
  v_add_u32 v140, s44, v140
  v_mul_u32_u24 v140, 1280, v140
  s_lshl_b32 s44, s43, 6
  s_add_u32 s44, s44, s41
  v_lshl_add_u32 v202, v142, 3, s44
  v_lshl_add_u32 v199, v202, 1, v140
  s_mul_i32 s45, s36, 4096
  s_add_u32 s45, s45, 98304
  v_lshl_add_u32 v201, v194, 4, s45
  v_lshlrev_b32 v140, 2, v145
  v_xor_b32 v140, v140, v141
  v_lshlrev_b32 v140, 4, v140
  v_lshl_add_u32 v140, v144, 7, v140
  v_add_u32 v200, s45, v140
  s_mov_b32 s80, 0
  s_mov_b32 s81, 10240
  s_mov_b32 s82, 20480
  s_mov_b32 s83, 30720
  v_lshrrev_b32 v140, 1, v144
  v_and_b32 v140, 7, v140
  v_xor_b32 v140, v140, v145
  v_lshlrev_b32 v140, 4, v140
  v_lshl_add_u32 v140, v144, 7, v140
  s_mul_i32 s44, s42, 4096
  v_add_u32 v140, s44, v140
  s_lshl_b32 s44, s36, 5
  v_xor_b32 v140, s44, v140
  v_xor_b32 v112, 0, v140
  v_xor_b32 v113, 32, v140
  v_xor_b32 v114, 64, v140
  v_xor_b32 v115, 96, v140
  v_bfe_u32 v140, v194, 2, 2
  v_lshl_add_u32 v141, v145, 3, v140
  v_mul_u32_u24 v141, 128, v141
  v_and_b32 v142, 1, v194
  v_lshlrev_b32 v142, 6, v142
  v_bfe_u32 v143, v194, 1, 1
  v_lshl_or_b32 v142, v143, 3, v142
  v_bfe_u32 v143, v194, 4, 1
  v_lshl_or_b32 v142, v143, 4, v142
  v_and_b32 v143, 2, v140
  v_lshlrev_b32 v143, 4, v143
  v_xor_b32 v142, v142, v143
  v_add_u32 v141, v141, v142
  v_add_u32 v141, 16384, v141
  s_mul_i32 s44, s36, 2048
  v_xor_b32 v141, s44, v141
  v_xor_b32 v116, 0, v141
  v_xor_b32 v117, 32, v141
  v_xor_b32 v118, 2048, v141
  v_xor_b32 v119, 2080, v141
  v_xor_b32 v120, 4096, v141
  v_xor_b32 v121, 4128, v141
  v_xor_b32 v122, 6144, v141
  v_xor_b32 v123, 6176, v141
  v_mov_b32 v188, v191
  v_mov_b32 v149, v190
  v_mov_b32 v140, 3840
  v_mov_b32 v150, 1280
  v_cmp_le_u32 vcc, 160, v202
  v_mov_b32 v151, 5120
  s_nop 0
  v_cndmask_b32 v140, v140, v150, vcc
  v_cmp_le_u32 vcc, 320, v202
  s_nop 1
  v_cndmask_b32 v140, v140, v151, vcc
  v_cmp_gt_u32 vcc, 480, v202
  s_nop 1
  v_cndmask_b32 v140, 0, v140, vcc
  v_add_u32 v199, v199, v140
  v_mov_b32 v148, 0x3f803f80
  v_mov_b32 v149, 0x3f803f80
  v_mov_b32 v140, 0
  v_bfe_u32 v142, v194, 2, 1
  v_lshlrev_b32 v142, 5, v142
  v_bfe_u32 v143, v194, 3, 2
  v_lshl_add_u32 v142, v143, 2, v142
  v_and_b32 v141, 3, v194
  v_add_u32 v142, v142, v141
  s_mov_b32 s44, 147456
  v_lshl_add_u32 v142, v142, 2, s44
  v_lshl_add_u32 v143, v145, 7, s44
  v_lshl_add_u32 v144, v194, 2, s44
  ds_write_b32 v144, v140
  s_mov_b64 exec, 0
  s_mov_b32 s50, 10
  s_cmp_eq_u32 s36, 1
  s_cbranch_scc1 A_q1
  s_cmp_eq_u32 s36, 2
  s_cbranch_scc1 A_q2
  s_cmp_eq_u32 s36, 3
  s_cbranch_scc1 A_q3
  s_branch A_loop
A_real:
  s_mov_b64 exec, -1
  s_mov_b32 s61, -98304
  s_mov_b32 s62, 49152
  s_nop 7
  s_nop 7
  v_mov_b32 v0, 0
  v_mov_b32 v1, 0
  v_mov_b32 v2, 0
  v_mov_b32 v3, 0
  v_mov_b32 v4, 0
  v_mov_b32 v5, 0
  v_mov_b32 v6, 0
  v_mov_b32 v7, 0
  v_mov_b32 v8, 0
  v_mov_b32 v9, 0
  v_mov_b32 v10, 0
  v_mov_b32 v11, 0
  v_mov_b32 v12, 0
  v_mov_b32 v13, 0
  v_mov_b32 v14, 0
  v_mov_b32 v15, 0
  v_mov_b32 v16, 0
  v_mov_b32 v17, 0
  v_mov_b32 v18, 0
  v_mov_b32 v19, 0
  v_mov_b32 v20, 0
  v_mov_b32 v21, 0
  v_mov_b32 v22, 0
  v_mov_b32 v23, 0
  v_mov_b32 v24, 0
  v_mov_b32 v25, 0
  v_mov_b32 v26, 0
  v_mov_b32 v27, 0
  v_mov_b32 v28, 0
  v_mov_b32 v29, 0
  v_mov_b32 v30, 0
  v_mov_b32 v31, 0
  v_mov_b32 v124, 0
  v_mov_b32 v125, 0
  v_mov_b32 v126, 0
  v_mov_b32 v127, 0
  v_mov_b32 v128, 0
  v_mov_b32 v129, 0
  v_mov_b32 v130, 0
  v_mov_b32 v131, 0
  v_mov_b32 v132, 0
  v_mov_b32 v133, 0
  v_mov_b32 v134, 0
  v_mov_b32 v135, 0
  v_mov_b32 v136, 0
  v_mov_b32 v137, 0
  v_mov_b32 v138, 0
  v_mov_b32 v139, 0
  s_mov_b32 s50, 0
  s_mov_b32 s51, 0
  s_waitcnt lgkmcnt(0)
  s_barrier
  ds_read_b128 v[64:67], v112 offset:0
  ds_read_b64_tr_b16 v[68:69], v116 offset:0
  ds_read_b64_tr_b16 v[70:71], v116 offset:512
  ds_read_b64_tr_b16 v[72:73], v117 offset:0
  ds_read_b64_tr_b16 v[74:75], v117 offset:512
  ds_read_b128 v[76:79], v113 offset:0
  ds_read_b64_tr_b16 v[80:81], v118 offset:0
  ds_read_b64_tr_b16 v[82:83], v118 offset:512
  ds_read_b64_tr_b16 v[84:85], v119 offset:0
  ds_read_b64_tr_b16 v[86:87], v119 offset:512
  ds_read_b128 v[88:91], v114 offset:0
  ds_read_b64_tr_b16 v[92:93], v120 offset:0
  ds_read_b64_tr_b16 v[94:95], v120 offset:512
  ds_read_b64_tr_b16 v[96:97], v121 offset:0
  ds_read_b64_tr_b16 v[98:99], v121 offset:512
A_loop:
  s_waitcnt lgkmcnt(10)
  v_mfma_f32_4x4x4_16b_bf16 v[124:127], v[148:149], v[64:65], v[124:127]
  v_mfma_f32_4x4x4_16b_bf16 v[128:131], v[64:65], v[64:65], v[128:131]
  v_mfma_f32_4x4x4_16b_bf16 v[132:135], v[148:149], v[68:69], v[132:135]
  v_mfma_f32_4x4x4_16b_bf16 v[136:139], v[148:149], v[72:73], v[136:139]
  v_mfma_f32_32x32x16_bf16 v[0:15], v[68:71], v[64:67], v[0:15]
  ds_read_b128 v[100:103], v115 offset:0
  s_add_u32 s51, s51, 2
  ds_read_b64_tr_b16 v[104:105], v122 offset:0
  s_cmp_eq_u32 s51, 6
  v_mfma_f32_4x4x4_16b_bf16 v[124:127], v[148:149], v[66:67], v[124:127]
  v_mfma_f32_4x4x4_16b_bf16 v[128:131], v[66:67], v[66:67], v[128:131]
  v_mfma_f32_4x4x4_16b_bf16 v[132:135], v[148:149], v[70:71], v[132:135]
  v_mfma_f32_4x4x4_16b_bf16 v[136:139], v[148:149], v[74:75], v[136:139]
  v_mfma_f32_32x32x16_bf16 v[16:31], v[72:75], v[64:67], v[16:31]
  ds_read_b64_tr_b16 v[106:107], v122 offset:512
  s_cselect_b32 s51, 0, s51
  ds_read_b64_tr_b16 v[108:109], v123 offset:0
  s_cselect_b32 s53, s61, s62
  ds_read_b64_tr_b16 v[110:111], v123 offset:512
  s_waitcnt lgkmcnt(10)
  v_mfma_f32_4x4x4_16b_bf16 v[124:127], v[148:149], v[76:77], v[124:127]
  v_mfma_f32_4x4x4_16b_bf16 v[128:131], v[76:77], v[76:77], v[128:131]
  v_mfma_f32_32x32x16_bf16 v[0:15], v[80:83], v[76:79], v[0:15]
  s_cbranch_execz A_g1
  s_barrier
A_g1:
  ds_read_b128 v[64:67], v112 offset:24576
  ds_read_b64_tr_b16 v[68:69], v116 offset:24576
  v_mfma_f32_4x4x4_16b_bf16 v[124:127], v[148:149], v[78:79], v[124:127]
  v_mfma_f32_4x4x4_16b_bf16 v[128:131], v[78:79], v[78:79], v[128:131]
  v_mfma_f32_32x32x16_bf16 v[16:31], v[84:87], v[76:79], v[16:31]
  ds_read_b64_tr_b16 v[70:71], v116 offset:25088
  ds_read_b64_tr_b16 v[72:73], v117 offset:24576
  ds_read_b64_tr_b16 v[74:75], v117 offset:25088
  s_waitcnt lgkmcnt(10)
  v_mfma_f32_4x4x4_16b_bf16 v[124:127], v[148:149], v[88:89], v[124:127]
  v_mfma_f32_4x4x4_16b_bf16 v[128:131], v[88:89], v[88:89], v[128:131]
  v_mfma_f32_32x32x16_bf16 v[0:15], v[92:95], v[88:91], v[0:15]
  ds_read_b128 v[76:79], v113 offset:24576
  ds_read_b64_tr_b16 v[80:81], v118 offset:24576
  v_mfma_f32_4x4x4_16b_bf16 v[124:127], v[148:149], v[90:91], v[124:127]
  v_mfma_f32_4x4x4_16b_bf16 v[128:131], v[90:91], v[90:91], v[128:131]
  v_mfma_f32_32x32x16_bf16 v[16:31], v[96:99], v[88:91], v[16:31]
  ds_read_b64_tr_b16 v[82:83], v118 offset:25088
  ds_read_b64_tr_b16 v[84:85], v119 offset:24576
  ds_read_b64_tr_b16 v[86:87], v119 offset:25088
  s_waitcnt lgkmcnt(10)
  v_mfma_f32_4x4x4_16b_bf16 v[124:127], v[148:149], v[100:101], v[124:127]
  v_mfma_f32_4x4x4_16b_bf16 v[128:131], v[100:101], v[100:101], v[128:131]
  v_mfma_f32_32x32x16_bf16 v[0:15], v[104:107], v[100:103], v[0:15]
  ds_read_b128 v[88:91], v114 offset:24576
  ds_read_b64_tr_b16 v[92:93], v120 offset:24576
  v_mfma_f32_4x4x4_16b_bf16 v[124:127], v[148:149], v[102:103], v[124:127]
  v_mfma_f32_4x4x4_16b_bf16 v[128:131], v[102:103], v[102:103], v[128:131]
  v_mfma_f32_32x32x16_bf16 v[16:31], v[108:111], v[100:103], v[16:31]
  ds_read_b64_tr_b16 v[94:95], v120 offset:25088
  ds_read_b64_tr_b16 v[96:97], v121 offset:24576
  ds_read_b64_tr_b16 v[98:99], v121 offset:25088
  s_waitcnt lgkmcnt(10)
  v_mfma_f32_4x4x4_16b_bf16 v[124:127], v[148:149], v[64:65], v[124:127]
  v_mfma_f32_4x4x4_16b_bf16 v[128:131], v[64:65], v[64:65], v[128:131]
  v_mfma_f32_4x4x4_16b_bf16 v[132:135], v[148:149], v[68:69], v[132:135]
  v_mfma_f32_4x4x4_16b_bf16 v[136:139], v[148:149], v[72:73], v[136:139]
  v_mfma_f32_32x32x16_bf16 v[0:15], v[68:71], v[64:67], v[0:15]
  ds_read_b128 v[100:103], v115 offset:24576
  ds_read_b64_tr_b16 v[104:105], v122 offset:24576
  ds_read_b64_tr_b16 v[106:107], v122 offset:25088
  ds_read_b64_tr_b16 v[108:109], v123 offset:24576
  v_mfma_f32_4x4x4_16b_bf16 v[124:127], v[148:149], v[66:67], v[124:127]
  v_mfma_f32_4x4x4_16b_bf16 v[128:131], v[66:67], v[66:67], v[128:131]
  v_mfma_f32_4x4x4_16b_bf16 v[132:135], v[148:149], v[70:71], v[132:135]
  v_mfma_f32_4x4x4_16b_bf16 v[136:139], v[148:149], v[74:75], v[136:139]
  v_mfma_f32_32x32x16_bf16 v[16:31], v[72:75], v[64:67], v[16:31]
  ds_read_b64_tr_b16 v[110:111], v123 offset:25088
  v_add_u32 v115, s53, v115
  v_add_u32 v122, s53, v122
  v_add_u32 v123, s53, v123
  s_waitcnt lgkmcnt(10)
  v_mfma_f32_4x4x4_16b_bf16 v[124:127], v[148:149], v[76:77], v[124:127]
  v_mfma_f32_4x4x4_16b_bf16 v[128:131], v[76:77], v[76:77], v[128:131]
  v_mfma_f32_32x32x16_bf16 v[0:15], v[80:83], v[76:79], v[0:15]
  s_cbranch_execz A_g2
  s_barrier
A_g2:
  v_add_u32 v112, s53, v112
  v_add_u32 v116, s53, v116
  v_add_u32 v117, s53, v117
  v_mfma_f32_4x4x4_16b_bf16 v[124:127], v[148:149], v[78:79], v[124:127]
  v_mfma_f32_4x4x4_16b_bf16 v[128:131], v[78:79], v[78:79], v[128:131]
  v_mfma_f32_32x32x16_bf16 v[16:31], v[84:87], v[76:79], v[16:31]
  ds_read_b128 v[64:67], v112 offset:0
  ds_read_b64_tr_b16 v[68:69], v116 offset:0
  ds_read_b64_tr_b16 v[70:71], v116 offset:512
  ds_read_b64_tr_b16 v[72:73], v117 offset:0
  ds_read_b64_tr_b16 v[74:75], v117 offset:512
  s_waitcnt lgkmcnt(10)
  v_mfma_f32_4x4x4_16b_bf16 v[124:127], v[148:149], v[88:89], v[124:127]
  v_mfma_f32_4x4x4_16b_bf16 v[128:131], v[88:89], v[88:89], v[128:131]
  v_mfma_f32_32x32x16_bf16 v[0:15], v[92:95], v[88:91], v[0:15]
  v_add_u32 v113, s53, v113
  v_add_u32 v118, s53, v118
  v_add_u32 v119, s53, v119
  ds_read_b128 v[76:79], v113 offset:0
  v_mfma_f32_4x4x4_16b_bf16 v[124:127], v[148:149], v[90:91], v[124:127]
  v_mfma_f32_4x4x4_16b_bf16 v[128:131], v[90:91], v[90:91], v[128:131]
  v_mfma_f32_32x32x16_bf16 v[16:31], v[96:99], v[88:91], v[16:31]
  ds_read_b64_tr_b16 v[80:81], v118 offset:0
  ds_read_b64_tr_b16 v[82:83], v118 offset:512
  ds_read_b64_tr_b16 v[84:85], v119 offset:0
  ds_read_b64_tr_b16 v[86:87], v119 offset:512
  s_add_u32 s50, s50, 2
  s_waitcnt lgkmcnt(10)
  v_mfma_f32_4x4x4_16b_bf16 v[124:127], v[148:149], v[100:101], v[124:127]
  v_mfma_f32_4x4x4_16b_bf16 v[128:131], v[100:101], v[100:101], v[128:131]
  v_mfma_f32_32x32x16_bf16 v[0:15], v[104:107], v[100:103], v[0:15]
  v_add_u32 v114, s53, v114
  v_add_u32 v120, s53, v120
  v_add_u32 v121, s53, v121
  ds_read_b128 v[88:91], v114 offset:0
  v_mfma_f32_4x4x4_16b_bf16 v[124:127], v[148:149], v[102:103], v[124:127]
  v_mfma_f32_4x4x4_16b_bf16 v[128:131], v[102:103], v[102:103], v[128:131]
  v_mfma_f32_32x32x16_bf16 v[16:31], v[108:111], v[100:103], v[16:31]
  ds_read_b64_tr_b16 v[92:93], v120 offset:0
  ds_read_b64_tr_b16 v[94:95], v120 offset:512
  ds_read_b64_tr_b16 v[96:97], v121 offset:0
  ds_read_b64_tr_b16 v[98:99], v121 offset:512
  s_cmp_lt_u32 s50, 10
  s_cbranch_scc1 A_loop
  s_cbranch_execz A_real
A_q1:
  s_waitcnt lgkmcnt(0)
  ds_add_f32 v142, v132
  ds_add_f32 v142, v136 offset:64
  v_cmp_eq_u32 vcc, 1, v141
  v_cmp_eq_u32 s[56:57], 2, v141
  v_cmp_eq_u32 s[58:59], 3, v141
  v_cndmask_b32 v128, v128, v129, vcc
  v_cndmask_b32 v128, v128, v130, s[56:57]
  v_cndmask_b32 v128, v128, v131, s[58:59]
  s_waitcnt lgkmcnt(0)
  s_cbranch_execz A_g3
  s_barrier
A_g3:
  ds_read_b128 v[156:159], v143 offset:0
  ds_read_b128 v[160:163], v143 offset:16
  ds_read_b128 v[164:167], v143 offset:32
  ds_read_b128 v[168:171], v143 offset:48
  ds_read_b128 v[172:175], v143 offset:64
  ds_read_b128 v[176:179], v143 offset:80
  ds_read_b128 v[180:183], v143 offset:96
  ds_read_b128 v[184:187], v143 offset:112
  v_mov_b32 v129, v128
  s_nop 1
  v_permlane32_swap_b32 v124, v125
  v_permlane32_swap_b32 v128, v129
  s_nop 1
  v_add_f32 v124, v124, v125
  v_add_f32 v128, v128, v129
  v_mul_f32 v124, 0x3acccccd, v124
  v_mul_f32 v128, 0x3acccccd, v128
  v_fma_f32 v128, -v124, v124, v128
  v_max_f32 v128, 0, v128
  v_add_f32 v144, 0x3727c5ac, v128
  v_rsq_f32 v144, v144
  s_nop 0
  v_mul_f32 v128, v128, v144
  v_mul_f32 v128, v128, v144
  v_add_f32 v128, 0x3727c5ac, v128
  v_rsq_f32 v128, v128
  v_mov_b32 v146, v124
  v_mov_b32 v147, v144
  v_mul_f32 v128, v128, v144
  s_cmp_lg_u32 s38, 0
  s_cbranch_scc1 A_nost
  s_cbranch_execz A_g4
  buffer_store_dwordx2 v[146:147], v188, s[28:31], 0 offen
A_g4:
A_nost:
  s_nop 1
  s_waitcnt lgkmcnt(0)
  v_sub_f32 v152, 0, v124
  v_rcp_f32 v154, v128
  v_mul_f32 v150, 0xc0135761, v128
  v_mul_f32 v151, v128, v128
  v_mul_f32 v151, v151, v150
  v_mul_f32 v151, 0x3d372713, v151
  s_mov_b32 s56, 0
  v_pk_fma_f32 v[0:1], v[156:157], v[152:153], v[0:1] op_sel_hi:[1,0,1]
  v_pk_fma_f32 v[2:3], v[158:159], v[152:153], v[2:3] op_sel_hi:[1,0,1]
  v_pk_fma_f32 v[4:5], v[160:161], v[152:153], v[4:5] op_sel_hi:[1,0,1]
  v_pk_fma_f32 v[6:7], v[162:163], v[152:153], v[6:7] op_sel_hi:[1,0,1]
  v_pk_mul_f32 v[64:65], v[0:1], v[0:1]
  v_pk_mul_f32 v[66:67], v[2:3], v[2:3]
  v_pk_mul_f32 v[68:69], v[4:5], v[4:5]
  v_pk_mul_f32 v[70:71], v[6:7], v[6:7]
  v_pk_fma_f32 v[64:65], v[64:65], v[150:151], v[150:151] op_sel:[0,1,0] op_sel_hi:[1,1,0]
  v_pk_fma_f32 v[66:67], v[66:67], v[150:151], v[150:151] op_sel:[0,1,0] op_sel_hi:[1,1,0]
  v_pk_fma_f32 v[68:69], v[68:69], v[150:151], v[150:151] op_sel:[0,1,0] op_sel_hi:[1,1,0]
  v_pk_fma_f32 v[70:71], v[70:71], v[150:151], v[150:151] op_sel:[0,1,0] op_sel_hi:[1,1,0]
  v_pk_mul_f32 v[64:65], v[64:65], v[0:1]
  v_pk_mul_f32 v[66:67], v[66:67], v[2:3]
  v_pk_mul_f32 v[68:69], v[68:69], v[4:5]
  v_pk_mul_f32 v[70:71], v[70:71], v[6:7]
  v_exp_f32 v64, v64
  v_exp_f32 v65, v65
  v_exp_f32 v66, v66
  v_exp_f32 v67, v67
  v_exp_f32 v68, v68
  v_exp_f32 v69, v69
  v_exp_f32 v70, v70
  v_exp_f32 v71, v71
  v_pk_fma_f32 v[64:65], v[64:65], v[154:155], v[154:155] op_sel_hi:[1,0,0]
  v_pk_fma_f32 v[66:67], v[66:67], v[154:155], v[154:155] op_sel_hi:[1,0,0]
  v_pk_fma_f32 v[68:69], v[68:69], v[154:155], v[154:155] op_sel_hi:[1,0,0]
  v_pk_fma_f32 v[70:71], v[70:71], v[154:155], v[154:155] op_sel_hi:[1,0,0]
  v_rcp_f32 v64, v64
  v_rcp_f32 v65, v65
  v_rcp_f32 v66, v66
  v_rcp_f32 v67, v67
  v_rcp_f32 v68, v68
  v_rcp_f32 v69, v69
  v_rcp_f32 v70, v70
  v_rcp_f32 v71, v71
  v_pk_mul_f32 v[64:65], v[64:65], v[0:1]
  v_pk_mul_f32 v[66:67], v[66:67], v[2:3]
  v_pk_mul_f32 v[68:69], v[68:69], v[4:5]
  v_pk_mul_f32 v[70:71], v[70:71], v[6:7]
  v_cvt_pk_bf16_f32 v72, v64, v65
  v_cvt_pk_bf16_f32 v73, v66, v67
  v_cvt_pk_bf16_f32 v74, v68, v69
  v_cvt_pk_bf16_f32 v75, v70, v71
  v_xor_b32 v112, 0, v200
  ds_write_b128 v112, v[72:75]
  s_cbranch_execz A_real
A_q2:
  v_pk_fma_f32 v[8:9], v[164:165], v[152:153], v[8:9] op_sel_hi:[1,0,1]
  v_pk_fma_f32 v[10:11], v[166:167], v[152:153], v[10:11] op_sel_hi:[1,0,1]
  v_pk_fma_f32 v[12:13], v[168:169], v[152:153], v[12:13] op_sel_hi:[1,0,1]
  v_pk_fma_f32 v[14:15], v[170:171], v[152:153], v[14:15] op_sel_hi:[1,0,1]
  v_pk_mul_f32 v[80:81], v[8:9], v[8:9]
  v_pk_mul_f32 v[82:83], v[10:11], v[10:11]
  v_pk_mul_f32 v[84:85], v[12:13], v[12:13]
  v_pk_mul_f32 v[86:87], v[14:15], v[14:15]
  v_pk_fma_f32 v[80:81], v[80:81], v[150:151], v[150:151] op_sel:[0,1,0] op_sel_hi:[1,1,0]
  v_pk_fma_f32 v[82:83], v[82:83], v[150:151], v[150:151] op_sel:[0,1,0] op_sel_hi:[1,1,0]
  v_pk_fma_f32 v[84:85], v[84:85], v[150:151], v[150:151] op_sel:[0,1,0] op_sel_hi:[1,1,0]
  v_pk_fma_f32 v[86:87], v[86:87], v[150:151], v[150:151] op_sel:[0,1,0] op_sel_hi:[1,1,0]
  v_pk_mul_f32 v[80:81], v[80:81], v[8:9]
  v_pk_mul_f32 v[82:83], v[82:83], v[10:11]
  v_pk_mul_f32 v[84:85], v[84:85], v[12:13]
  v_pk_mul_f32 v[86:87], v[86:87], v[14:15]
  v_exp_f32 v80, v80
  v_exp_f32 v81, v81
  v_exp_f32 v82, v82
  v_exp_f32 v83, v83
  v_exp_f32 v84, v84
  v_exp_f32 v85, v85
  v_exp_f32 v86, v86
  v_exp_f32 v87, v87
  v_pk_fma_f32 v[80:81], v[80:81], v[154:155], v[154:155] op_sel_hi:[1,0,0]
  v_pk_fma_f32 v[82:83], v[82:83], v[154:155], v[154:155] op_sel_hi:[1,0,0]
  v_pk_fma_f32 v[84:85], v[84:85], v[154:155], v[154:155] op_sel_hi:[1,0,0]
  v_pk_fma_f32 v[86:87], v[86:87], v[154:155], v[154:155] op_sel_hi:[1,0,0]
  v_rcp_f32 v80, v80
  v_rcp_f32 v81, v81
  v_rcp_f32 v82, v82
  v_rcp_f32 v83, v83
  v_rcp_f32 v84, v84
  v_rcp_f32 v85, v85
  v_rcp_f32 v86, v86
  v_rcp_f32 v87, v87
  v_pk_mul_f32 v[80:81], v[80:81], v[8:9]
  v_pk_mul_f32 v[82:83], v[82:83], v[10:11]
  v_pk_mul_f32 v[84:85], v[84:85], v[12:13]
  v_pk_mul_f32 v[86:87], v[86:87], v[14:15]
  v_cvt_pk_bf16_f32 v88, v80, v81
  v_cvt_pk_bf16_f32 v89, v82, v83
  v_cvt_pk_bf16_f32 v90, v84, v85
  v_cvt_pk_bf16_f32 v91, v86, v87
  v_xor_b32 v113, 16, v200
  ds_write_b128 v113, v[88:91]
  v_pk_fma_f32 v[16:17], v[172:173], v[152:153], v[16:17] op_sel_hi:[1,0,1]
  v_pk_fma_f32 v[18:19], v[174:175], v[152:153], v[18:19] op_sel_hi:[1,0,1]
  v_pk_fma_f32 v[20:21], v[176:177], v[152:153], v[20:21] op_sel_hi:[1,0,1]
  v_pk_fma_f32 v[22:23], v[178:179], v[152:153], v[22:23] op_sel_hi:[1,0,1]
  v_pk_mul_f32 v[64:65], v[16:17], v[16:17]
  v_pk_mul_f32 v[66:67], v[18:19], v[18:19]
  v_pk_mul_f32 v[68:69], v[20:21], v[20:21]
  v_pk_mul_f32 v[70:71], v[22:23], v[22:23]
  v_pk_fma_f32 v[64:65], v[64:65], v[150:151], v[150:151] op_sel:[0,1,0] op_sel_hi:[1,1,0]
  v_pk_fma_f32 v[66:67], v[66:67], v[150:151], v[150:151] op_sel:[0,1,0] op_sel_hi:[1,1,0]
  v_pk_fma_f32 v[68:69], v[68:69], v[150:151], v[150:151] op_sel:[0,1,0] op_sel_hi:[1,1,0]
  v_pk_fma_f32 v[70:71], v[70:71], v[150:151], v[150:151] op_sel:[0,1,0] op_sel_hi:[1,1,0]
  v_pk_mul_f32 v[64:65], v[64:65], v[16:17]
  v_pk_mul_f32 v[66:67], v[66:67], v[18:19]
  v_pk_mul_f32 v[68:69], v[68:69], v[20:21]
  v_pk_mul_f32 v[70:71], v[70:71], v[22:23]
  v_exp_f32 v64, v64
  v_exp_f32 v65, v65
  v_exp_f32 v66, v66
  v_exp_f32 v67, v67
  v_exp_f32 v68, v68
  v_exp_f32 v69, v69
  v_exp_f32 v70, v70
  v_exp_f32 v71, v71
  v_pk_fma_f32 v[64:65], v[64:65], v[154:155], v[154:155] op_sel_hi:[1,0,0]
  v_pk_fma_f32 v[66:67], v[66:67], v[154:155], v[154:155] op_sel_hi:[1,0,0]
  v_pk_fma_f32 v[68:69], v[68:69], v[154:155], v[154:155] op_sel_hi:[1,0,0]
  v_pk_fma_f32 v[70:71], v[70:71], v[154:155], v[154:155] op_sel_hi:[1,0,0]
  v_rcp_f32 v64, v64
  v_rcp_f32 v65, v65
  v_rcp_f32 v66, v66
  v_rcp_f32 v67, v67
  v_rcp_f32 v68, v68
  v_rcp_f32 v69, v69
  v_rcp_f32 v70, v70
  v_rcp_f32 v71, v71
  v_pk_mul_f32 v[64:65], v[64:65], v[16:17]
  v_pk_mul_f32 v[66:67], v[66:67], v[18:19]
  v_pk_mul_f32 v[68:69], v[68:69], v[20:21]
  v_pk_mul_f32 v[70:71], v[70:71], v[22:23]
  v_cvt_pk_bf16_f32 v72, v64, v65
  v_cvt_pk_bf16_f32 v73, v66, v67
  v_cvt_pk_bf16_f32 v74, v68, v69
  v_cvt_pk_bf16_f32 v75, v70, v71
  v_xor_b32 v114, 32, v200
  ds_write_b128 v114, v[72:75]
  s_cbranch_execz A_real
A_q3:
  v_pk_fma_f32 v[24:25], v[180:181], v[152:153], v[24:25] op_sel_hi:[1,0,1]
  v_pk_fma_f32 v[26:27], v[182:183], v[152:153], v[26:27] op_sel_hi:[1,0,1]
  v_pk_fma_f32 v[28:29], v[184:185], v[152:153], v[28:29] op_sel_hi:[1,0,1]
  v_pk_fma_f32 v[30:31], v[186:187], v[152:153], v[30:31] op_sel_hi:[1,0,1]
  v_pk_mul_f32 v[80:81], v[24:25], v[24:25]
  v_pk_mul_f32 v[82:83], v[26:27], v[26:27]
  v_pk_mul_f32 v[84:85], v[28:29], v[28:29]
  v_pk_mul_f32 v[86:87], v[30:31], v[30:31]
  v_pk_fma_f32 v[80:81], v[80:81], v[150:151], v[150:151] op_sel:[0,1,0] op_sel_hi:[1,1,0]
  v_pk_fma_f32 v[82:83], v[82:83], v[150:151], v[150:151] op_sel:[0,1,0] op_sel_hi:[1,1,0]
  v_pk_fma_f32 v[84:85], v[84:85], v[150:151], v[150:151] op_sel:[0,1,0] op_sel_hi:[1,1,0]
  v_pk_fma_f32 v[86:87], v[86:87], v[150:151], v[150:151] op_sel:[0,1,0] op_sel_hi:[1,1,0]
  v_pk_mul_f32 v[80:81], v[80:81], v[24:25]
  v_pk_mul_f32 v[82:83], v[82:83], v[26:27]
  v_pk_mul_f32 v[84:85], v[84:85], v[28:29]
  v_pk_mul_f32 v[86:87], v[86:87], v[30:31]
  v_exp_f32 v80, v80
  v_exp_f32 v81, v81
  v_exp_f32 v82, v82
  v_exp_f32 v83, v83
  v_exp_f32 v84, v84
  v_exp_f32 v85, v85
  v_exp_f32 v86, v86
  v_exp_f32 v87, v87
  v_pk_fma_f32 v[80:81], v[80:81], v[154:155], v[154:155] op_sel_hi:[1,0,0]
  v_pk_fma_f32 v[82:83], v[82:83], v[154:155], v[154:155] op_sel_hi:[1,0,0]
  v_pk_fma_f32 v[84:85], v[84:85], v[154:155], v[154:155] op_sel_hi:[1,0,0]
  v_pk_fma_f32 v[86:87], v[86:87], v[154:155], v[154:155] op_sel_hi:[1,0,0]
  v_rcp_f32 v80, v80
  v_rcp_f32 v81, v81
  v_rcp_f32 v82, v82
  v_rcp_f32 v83, v83
  v_rcp_f32 v84, v84
  v_rcp_f32 v85, v85
  v_rcp_f32 v86, v86
  v_rcp_f32 v87, v87
  v_pk_mul_f32 v[80:81], v[80:81], v[24:25]
  v_pk_mul_f32 v[82:83], v[82:83], v[26:27]
  v_pk_mul_f32 v[84:85], v[84:85], v[28:29]
  v_pk_mul_f32 v[86:87], v[86:87], v[30:31]
  v_cvt_pk_bf16_f32 v88, v80, v81
  v_cvt_pk_bf16_f32 v89, v82, v83
  v_cvt_pk_bf16_f32 v90, v84, v85
  v_cvt_pk_bf16_f32 v91, v86, v87
  v_xor_b32 v115, 48, v200
  ds_write_b128 v115, v[88:91]
  ds_read_b128 v[0:3], v201 offset:0
  ds_read_b128 v[4:7], v201 offset:1024
  ds_read_b128 v[8:11], v201 offset:2048
  ds_read_b128 v[12:15], v201 offset:3072
  s_waitcnt lgkmcnt(3)
  s_cbranch_execz A_g5
  buffer_store_dwordx4 v[0:3], v199, s[16:19], s80 offen
A_g5:
  s_waitcnt lgkmcnt(2)
  s_cbranch_execz A_g6
  buffer_store_dwordx4 v[4:7], v199, s[16:19], s81 offen
A_g6:
  s_waitcnt lgkmcnt(1)
  s_cbranch_execz A_g7
  buffer_store_dwordx4 v[8:11], v199, s[16:19], s82 offen
A_g7:
  s_waitcnt lgkmcnt(0)
  s_cbranch_execz A_g8
  buffer_store_dwordx4 v[12:15], v199, s[16:19], s83 offen
A_g8:
  s_cbranch_execz A_real
  s_waitcnt vmcnt(0) lgkmcnt(0)
  s_endpgm
A_side:
  s_sub_u32 s2, s2, 160
  s_cmp_ge_u32 s2, 92
  s_cbranch_scc1 A_end
  s_cmp_ge_u32 s2, 80
  s_cbranch_scc1 P_cs
  s_load_dwordx2 s[4:5], s[0:1], 104
  s_load_dwordx4 s[32:35], s[0:1], 8
  s_load_dwordx4 s[44:47], s[0:1], 24
  s_and_b32 s37, s2, 7
  s_lshr_b32 s38, s2, 3
  v_mov_b32 v130, v0
  s_and_b32 s36, s60, 3
  s_lshr_b32 s39, s60, 2
  v_and_b32 v121, 7, v130
  v_lshrrev_b32 v120, 3, v130
  v_xor_b32 v121, 7, v121
  s_lshl_b32 s40, s37, 8
  s_lshl_b32 s41, s36, 6
  s_add_u32 s40, s40, s41
  v_lshl_add_u32 v121, v121, 3, s40
  s_lshl_b32 s41, s38, 4
  s_lshl_b32 s42, s39, 3
  s_add_u32 s41, s41, s42
  v_add_u32 v120, s41, v120
  v_mul_u32_u24 v122, 1280, v121
  v_lshl_add_u32 v122, v120, 3, v122
  v_lshlrev_b32 v123, 5, v120
  s_waitcnt lgkmcnt(0)
  s_mov_b32 s8, s32
  s_mov_b32 s9, s33
  s_mov_b32 s10, 0x280000
  s_mov_b32 s11, 0x00020000
  s_mov_b32 s12, s34
  s_mov_b32 s13, s35
  s_mov_b32 s14, 0x280000
  s_mov_b32 s15, 0x00020000
  s_mov_b32 s16, s44
  s_mov_b32 s17, s45
  s_mov_b32 s18, 0x1400
  s_mov_b32 s19, 0x00020000
  s_add_u32 s20, s4, 0x2a0000
  s_addc_u32 s21, s5, 0
  s_mov_b32 s22, 0x528000
  s_mov_b32 s23, 0x00020000
  v_add_u32 v124, -5120, v122
  buffer_load_dwordx2 v[0:1], v124, s[8:11], 0 offen
  v_add_u32 v124, -3840, v122
  buffer_load_dwordx2 v[2:3], v124, s[8:11], 0 offen
  v_add_u32 v124, -2560, v122
  buffer_load_dwordx2 v[4:5], v124, s[8:11], 0 offen
  v_add_u32 v124, -1280, v122
  buffer_load_dwordx2 v[6:7], v124, s[8:11], 0 offen
  buffer_load_dwordx2 v[24:25], v124, s[12:15], 0 offen
  v_add_u32 v124, 0, v122
  buffer_load_dwordx2 v[8:9], v124, s[8:11], 0 offen
  buffer_load_dwordx2 v[26:27], v124, s[12:15], 0 offen
  v_add_u32 v124, 1280, v122
  buffer_load_dwordx2 v[10:11], v124, s[8:11], 0 offen
  buffer_load_dwordx2 v[28:29], v124, s[12:15], 0 offen
  v_add_u32 v124, 2560, v122
  buffer_load_dwordx2 v[12:13], v124, s[8:11], 0 offen
  buffer_load_dwordx2 v[30:31], v124, s[12:15], 0 offen
  v_add_u32 v124, 3840, v122
  buffer_load_dwordx2 v[14:15], v124, s[8:11], 0 offen
  buffer_load_dwordx2 v[32:33], v124, s[12:15], 0 offen
  v_add_u32 v124, 5120, v122
  buffer_load_dwordx2 v[16:17], v124, s[8:11], 0 offen
  buffer_load_dwordx2 v[34:35], v124, s[12:15], 0 offen
  v_add_u32 v124, 6400, v122
  buffer_load_dwordx2 v[18:19], v124, s[8:11], 0 offen
  buffer_load_dwordx2 v[36:37], v124, s[12:15], 0 offen
  v_add_u32 v124, 7680, v122
  buffer_load_dwordx2 v[20:21], v124, s[8:11], 0 offen
  buffer_load_dwordx2 v[38:39], v124, s[12:15], 0 offen
  v_add_u32 v124, 8960, v122
  buffer_load_dwordx2 v[22:23], v124, s[8:11], 0 offen
  buffer_load_dwordx2 v[40:41], v124, s[12:15], 0 offen
  buffer_load_dwordx4 v[44:47], v123, s[16:19], 0 offen offset:0
  buffer_load_dwordx4 v[48:51], v123, s[16:19], 0 offen offset:16
  v_mul_u32_u24 v125, 16896, v120
  v_sub_u32 v126, 2040, v121
  v_lshl_add_u32 v125, v126, 1, v125
  s_mov_b32 s54, 0xffff0000
  s_waitcnt vmcnt(0)
  s_mov_b32 s8, s46
  s_mov_b32 s9, s47
  s_mov_b32 s10, 0x280000
  s_mov_b32 s11, 0x00020000
  s_lshl_b32 s42, s2, 3
  s_add_u32 s42, s42, s60
  s_lshl_b32 s42, s42, 12
  v_lshlrev_b32 v128, 6, v130
  buffer_load_dword v129, v128, s[8:11], s42 offen sc1
  v_lshlrev_b32 v76, 16, v44
  v_and_b32 v78, s54, v44
  v_lshlrev_b32 v80, 16, v45
  v_and_b32 v82, s54, v45
  v_lshlrev_b32 v77, 16, v46
  v_and_b32 v79, s54, v46
  v_lshlrev_b32 v81, 16, v47
  v_and_b32 v83, s54, v47
  v_lshlrev_b32 v52, 16, v0
  v_and_b32 v53, s54, v0
  v_lshlrev_b32 v54, 16, v2
  v_and_b32 v55, s54, v2
  v_lshlrev_b32 v56, 16, v4
  v_and_b32 v57, s54, v4
  v_lshlrev_b32 v58, 16, v6
  v_and_b32 v59, s54, v6
  v_lshlrev_b32 v60, 16, v8
  v_and_b32 v61, s54, v8
  v_lshlrev_b32 v62, 16, v10
  v_and_b32 v63, s54, v10
  v_lshlrev_b32 v64, 16, v12
  v_and_b32 v65, s54, v12
  v_lshlrev_b32 v66, 16, v14
  v_and_b32 v67, s54, v14
  v_lshlrev_b32 v68, 16, v16
  v_and_b32 v69, s54, v16
  v_lshlrev_b32 v70, 16, v18
  v_and_b32 v71, s54, v18
  v_lshlrev_b32 v72, 16, v20
  v_and_b32 v73, s54, v20
  v_lshlrev_b32 v74, 16, v22
  v_and_b32 v75, s54, v22
  v_pk_mul_f32 v[84:85], v[58:59], v[76:77]
  v_pk_mul_f32 v[86:87], v[60:61], v[76:77]
  v_pk_mul_f32 v[88:89], v[62:63], v[76:77]
  v_pk_mul_f32 v[90:91], v[64:65], v[76:77]
  v_pk_mul_f32 v[92:93], v[66:67], v[76:77]
  v_pk_mul_f32 v[94:95], v[68:69], v[76:77]
  v_pk_mul_f32 v[96:97], v[70:71], v[76:77]
  v_pk_mul_f32 v[98:99], v[72:73], v[76:77]
  v_pk_mul_f32 v[100:101], v[74:75], v[76:77]
  v_pk_fma_f32 v[84:85], v[56:57], v[78:79], v[84:85]
  v_pk_fma_f32 v[86:87], v[58:59], v[78:79], v[86:87]
  v_pk_fma_f32 v[88:89], v[60:61], v[78:79], v[88:89]
  v_pk_fma_f32 v[90:91], v[62:63], v[78:79], v[90:91]
  v_pk_fma_f32 v[92:93], v[64:65], v[78:79], v[92:93]
  v_pk_fma_f32 v[94:95], v[66:67], v[78:79], v[94:95]
  v_pk_fma_f32 v[96:97], v[68:69], v[78:79], v[96:97]
  v_pk_fma_f32 v[98:99], v[70:71], v[78:79], v[98:99]
  v_pk_fma_f32 v[100:101], v[72:73], v[78:79], v[100:101]
  v_pk_fma_f32 v[84:85], v[54:55], v[80:81], v[84:85]
  v_pk_fma_f32 v[86:87], v[56:57], v[80:81], v[86:87]
  v_pk_fma_f32 v[88:89], v[58:59], v[80:81], v[88:89]
  v_pk_fma_f32 v[90:91], v[60:61], v[80:81], v[90:91]
  v_pk_fma_f32 v[92:93], v[62:63], v[80:81], v[92:93]
  v_pk_fma_f32 v[94:95], v[64:65], v[80:81], v[94:95]
  v_pk_fma_f32 v[96:97], v[66:67], v[80:81], v[96:97]
  v_pk_fma_f32 v[98:99], v[68:69], v[80:81], v[98:99]
  v_pk_fma_f32 v[100:101], v[70:71], v[80:81], v[100:101]
  v_pk_fma_f32 v[84:85], v[52:53], v[82:83], v[84:85]
  v_pk_fma_f32 v[86:87], v[54:55], v[82:83], v[86:87]
  v_pk_fma_f32 v[88:89], v[56:57], v[82:83], v[88:89]
  v_pk_fma_f32 v[90:91], v[58:59], v[82:83], v[90:91]
  v_pk_fma_f32 v[92:93], v[60:61], v[82:83], v[92:93]
  v_pk_fma_f32 v[94:95], v[62:63], v[82:83], v[94:95]
  v_pk_fma_f32 v[96:97], v[64:65], v[82:83], v[96:97]
  v_pk_fma_f32 v[98:99], v[66:67], v[82:83], v[98:99]
  v_pk_fma_f32 v[100:101], v[68:69], v[82:83], v[100:101]
  v_lshlrev_b32 v52, 16, v24
  v_and_b32 v53, s54, v24
  v_lshlrev_b32 v54, 16, v26
  v_and_b32 v55, s54, v26
  v_lshlrev_b32 v56, 16, v28
  v_and_b32 v57, s54, v28
  v_lshlrev_b32 v58, 16, v30
  v_and_b32 v59, s54, v30
  v_lshlrev_b32 v60, 16, v32
  v_and_b32 v61, s54, v32
  v_lshlrev_b32 v62, 16, v34
  v_and_b32 v63, s54, v34
  v_lshlrev_b32 v64, 16, v36
  v_and_b32 v65, s54, v36
  v_lshlrev_b32 v66, 16, v38
  v_and_b32 v67, s54, v38
  v_lshlrev_b32 v68, 16, v40
  v_and_b32 v69, s54, v40
  v_pk_mul_f32 v[84:85], v[84:85], v[52:53]
  v_pk_mul_f32 v[86:87], v[86:87], v[54:55]
  v_pk_mul_f32 v[88:89], v[88:89], v[56:57]
  v_pk_mul_f32 v[90:91], v[90:91], v[58:59]
  v_pk_mul_f32 v[92:93], v[92:93], v[60:61]
  v_pk_mul_f32 v[94:95], v[94:95], v[62:63]
  v_pk_mul_f32 v[96:97], v[96:97], v[64:65]
  v_pk_mul_f32 v[98:99], v[98:99], v[66:67]
  v_pk_mul_f32 v[100:101], v[100:101], v[68:69]
  v_cvt_pk_bf16_f32 v104, v100, v98
  v_cvt_pk_bf16_f32 v105, v96, v94
  v_cvt_pk_bf16_f32 v106, v92, v90
  v_cvt_pk_bf16_f32 v107, v88, v86
  v_cvt_pk_bf16_f32 v108, v98, v96
  v_cvt_pk_bf16_f32 v109, v94, v92
  v_cvt_pk_bf16_f32 v110, v90, v88
  v_cvt_pk_bf16_f32 v111, v86, v84
  s_mov_b32 s56, 0
  s_mov_b32 s57, 2703360
  buffer_store_dwordx4 v[104:107], v125, s[20:23], s56 offen
  buffer_store_dwordx4 v[108:111], v125, s[20:23], s57 offen
  v_cvt_pk_bf16_f32 v112, v101, v99
  v_cvt_pk_bf16_f32 v113, v97, v95
  v_cvt_pk_bf16_f32 v114, v93, v91
  v_cvt_pk_bf16_f32 v115, v89, v87
  v_cvt_pk_bf16_f32 v116, v99, v97
  v_cvt_pk_bf16_f32 v117, v95, v93
  v_cvt_pk_bf16_f32 v118, v91, v89
  v_cvt_pk_bf16_f32 v119, v87, v85
  s_mov_b32 s56, 4224
  s_mov_b32 s57, 2707584
  buffer_store_dwordx4 v[112:115], v125, s[20:23], s56 offen
  buffer_store_dwordx4 v[116:119], v125, s[20:23], s57 offen
  v_lshlrev_b32 v76, 16, v48
  v_and_b32 v78, s54, v48
  v_lshlrev_b32 v80, 16, v49
  v_and_b32 v82, s54, v49
  v_lshlrev_b32 v77, 16, v50
  v_and_b32 v79, s54, v50
  v_lshlrev_b32 v81, 16, v51
  v_and_b32 v83, s54, v51
  v_lshlrev_b32 v52, 16, v1
  v_and_b32 v53, s54, v1
  v_lshlrev_b32 v54, 16, v3
  v_and_b32 v55, s54, v3
  v_lshlrev_b32 v56, 16, v5
  v_and_b32 v57, s54, v5
  v_lshlrev_b32 v58, 16, v7
  v_and_b32 v59, s54, v7
  v_lshlrev_b32 v60, 16, v9
  v_and_b32 v61, s54, v9
  v_lshlrev_b32 v62, 16, v11
  v_and_b32 v63, s54, v11
  v_lshlrev_b32 v64, 16, v13
  v_and_b32 v65, s54, v13
  v_lshlrev_b32 v66, 16, v15
  v_and_b32 v67, s54, v15
  v_lshlrev_b32 v68, 16, v17
  v_and_b32 v69, s54, v17
  v_lshlrev_b32 v70, 16, v19
  v_and_b32 v71, s54, v19
  v_lshlrev_b32 v72, 16, v21
  v_and_b32 v73, s54, v21
  v_lshlrev_b32 v74, 16, v23
  v_and_b32 v75, s54, v23
  v_pk_mul_f32 v[84:85], v[58:59], v[76:77]
  v_pk_mul_f32 v[86:87], v[60:61], v[76:77]
  v_pk_mul_f32 v[88:89], v[62:63], v[76:77]
  v_pk_mul_f32 v[90:91], v[64:65], v[76:77]
  v_pk_mul_f32 v[92:93], v[66:67], v[76:77]
  v_pk_mul_f32 v[94:95], v[68:69], v[76:77]
  v_pk_mul_f32 v[96:97], v[70:71], v[76:77]
  v_pk_mul_f32 v[98:99], v[72:73], v[76:77]
  v_pk_mul_f32 v[100:101], v[74:75], v[76:77]
  v_pk_fma_f32 v[84:85], v[56:57], v[78:79], v[84:85]
  v_pk_fma_f32 v[86:87], v[58:59], v[78:79], v[86:87]
  v_pk_fma_f32 v[88:89], v[60:61], v[78:79], v[88:89]
  v_pk_fma_f32 v[90:91], v[62:63], v[78:79], v[90:91]
  v_pk_fma_f32 v[92:93], v[64:65], v[78:79], v[92:93]
  v_pk_fma_f32 v[94:95], v[66:67], v[78:79], v[94:95]
  v_pk_fma_f32 v[96:97], v[68:69], v[78:79], v[96:97]
  v_pk_fma_f32 v[98:99], v[70:71], v[78:79], v[98:99]
  v_pk_fma_f32 v[100:101], v[72:73], v[78:79], v[100:101]
  v_pk_fma_f32 v[84:85], v[54:55], v[80:81], v[84:85]
  v_pk_fma_f32 v[86:87], v[56:57], v[80:81], v[86:87]
  v_pk_fma_f32 v[88:89], v[58:59], v[80:81], v[88:89]
  v_pk_fma_f32 v[90:91], v[60:61], v[80:81], v[90:91]
  v_pk_fma_f32 v[92:93], v[62:63], v[80:81], v[92:93]
  v_pk_fma_f32 v[94:95], v[64:65], v[80:81], v[94:95]
  v_pk_fma_f32 v[96:97], v[66:67], v[80:81], v[96:97]
  v_pk_fma_f32 v[98:99], v[68:69], v[80:81], v[98:99]
  v_pk_fma_f32 v[100:101], v[70:71], v[80:81], v[100:101]
  v_pk_fma_f32 v[84:85], v[52:53], v[82:83], v[84:85]
  v_pk_fma_f32 v[86:87], v[54:55], v[82:83], v[86:87]
  v_pk_fma_f32 v[88:89], v[56:57], v[82:83], v[88:89]
  v_pk_fma_f32 v[90:91], v[58:59], v[82:83], v[90:91]
  v_pk_fma_f32 v[92:93], v[60:61], v[82:83], v[92:93]
  v_pk_fma_f32 v[94:95], v[62:63], v[82:83], v[94:95]
  v_pk_fma_f32 v[96:97], v[64:65], v[82:83], v[96:97]
  v_pk_fma_f32 v[98:99], v[66:67], v[82:83], v[98:99]
  v_pk_fma_f32 v[100:101], v[68:69], v[82:83], v[100:101]
  v_lshlrev_b32 v52, 16, v25
  v_and_b32 v53, s54, v25
  v_lshlrev_b32 v54, 16, v27
  v_and_b32 v55, s54, v27
  v_lshlrev_b32 v56, 16, v29
  v_and_b32 v57, s54, v29
  v_lshlrev_b32 v58, 16, v31
  v_and_b32 v59, s54, v31
  v_lshlrev_b32 v60, 16, v33
  v_and_b32 v61, s54, v33
  v_lshlrev_b32 v62, 16, v35
  v_and_b32 v63, s54, v35
  v_lshlrev_b32 v64, 16, v37
  v_and_b32 v65, s54, v37
  v_lshlrev_b32 v66, 16, v39
  v_and_b32 v67, s54, v39
  v_lshlrev_b32 v68, 16, v41
  v_and_b32 v69, s54, v41
  v_pk_mul_f32 v[84:85], v[84:85], v[52:53]
  v_pk_mul_f32 v[86:87], v[86:87], v[54:55]
  v_pk_mul_f32 v[88:89], v[88:89], v[56:57]
  v_pk_mul_f32 v[90:91], v[90:91], v[58:59]
  v_pk_mul_f32 v[92:93], v[92:93], v[60:61]
  v_pk_mul_f32 v[94:95], v[94:95], v[62:63]
  v_pk_mul_f32 v[96:97], v[96:97], v[64:65]
  v_pk_mul_f32 v[98:99], v[98:99], v[66:67]
  v_pk_mul_f32 v[100:101], v[100:101], v[68:69]
  v_cvt_pk_bf16_f32 v104, v100, v98
  v_cvt_pk_bf16_f32 v105, v96, v94
  v_cvt_pk_bf16_f32 v106, v92, v90
  v_cvt_pk_bf16_f32 v107, v88, v86
  v_cvt_pk_bf16_f32 v108, v98, v96
  v_cvt_pk_bf16_f32 v109, v94, v92
  v_cvt_pk_bf16_f32 v110, v90, v88
  v_cvt_pk_bf16_f32 v111, v86, v84
  s_mov_b32 s56, 8448
  s_mov_b32 s57, 2711808
  buffer_store_dwordx4 v[104:107], v125, s[20:23], s56 offen
  buffer_store_dwordx4 v[108:111], v125, s[20:23], s57 offen
  v_cvt_pk_bf16_f32 v112, v101, v99
  v_cvt_pk_bf16_f32 v113, v97, v95
  v_cvt_pk_bf16_f32 v114, v93, v91
  v_cvt_pk_bf16_f32 v115, v89, v87
  v_cvt_pk_bf16_f32 v116, v99, v97
  v_cvt_pk_bf16_f32 v117, v95, v93
  v_cvt_pk_bf16_f32 v118, v91, v89
  v_cvt_pk_bf16_f32 v119, v87, v85
  s_mov_b32 s56, 12672
  s_mov_b32 s57, 2716032
  buffer_store_dwordx4 v[112:115], v125, s[20:23], s56 offen
  buffer_store_dwordx4 v[116:119], v125, s[20:23], s57 offen
  v_mov_b32 v0, 0
  v_mov_b32 v1, 0
  v_mov_b32 v2, 0
  v_mov_b32 v3, 0
  s_cmp_lg_u32 s37, 0
  s_cbranch_scc1 P_nz
  v_lshrrev_b32 v126, 3, v130
  s_lshl_b32 s41, s38, 6
  s_lshl_b32 s42, s60, 3
  s_add_u32 s41, s41, s42
  v_add_u32 v126, s41, v126
  v_mul_u32_u24 v126, 4224, v126
  v_and_b32 v127, 7, v130
  v_lshl_add_u32 v126, v127, 4, v126
  s_mov_b32 s55, 4096
  s_mov_b32 s56, 2707456
  buffer_store_dwordx4 v[0:3], v126, s[20:23], s55 offen
  buffer_store_dwordx4 v[0:3], v126, s[20:23], s56 offen
  s_add_u32 s41, s38, s60
  s_cmp_lg_u32 s41, 0
  s_cbranch_scc1 P_nz
  s_mov_b32 s24, s4
  s_mov_b32 s25, s5
  s_mov_b32 s26, 0x281400
  s_mov_b32 s27, 0x00020000
  v_lshlrev_b32 v126, 4, v130
  s_mov_b64 exec, 0xfffff
  s_mov_b32 s58, 2560
  buffer_store_dwordx4 v[0:3], v126, s[24:27], s58 offen
  s_mov_b32 s58, 2623040
  buffer_store_dwordx4 v[0:3], v126, s[24:27], s58 offen
  s_mov_b32 s58, 3200
  buffer_store_dwordx4 v[0:3], v126, s[24:27], s58 offen
  s_mov_b32 s58, 4480
  buffer_store_dwordx4 v[0:3], v126, s[24:27], s58 offen
  s_mov_b32 s58, 2622400
  buffer_store_dwordx4 v[0:3], v126, s[24:27], s58 offen
  s_mov_b32 s58, 2623680
  buffer_store_dwordx4 v[0:3], v126, s[24:27], s58 offen
  s_mov_b64 exec, -1
P_nz:
  s_waitcnt vmcnt(0) lgkmcnt(0)
  s_endpgm
P_cs:
  s_load_dwordx2 s[4:5], s[0:1], 104
  s_load_dwordx2 s[6:7], s[0:1], 72
  s_sub_u32 s37, s2, 80
  s_lshl_b32 s38, s37, 8
  v_lshl_add_u32 v1, s60, 6, v0
  v_lshrrev_b32 v2, 4, v1
  v_and_b32 v3, 15, v1
  v_mul_u32_u24 v2, 3072, v2
  v_lshl_add_u32 v2, v3, 4, v2
  v_lshlrev_b32 v3, 5, v3
  v_lshlrev_b32 v1, 2, v1
  s_mov_b32 s54, 0xffff0000
  s_waitcnt lgkmcnt(0)
  s_mov_b32 s8, s6
  s_mov_b32 s9, s7
  s_mov_b32 s10, 0x1e0000
  s_mov_b32 s11, 0x00020000
  s_add_u32 s12, s4, 0x1540000
  s_addc_u32 s13, s5, 0
  s_mov_b32 s14, 0x1800
  s_mov_b32 s15, 0x00020000
  buffer_load_dwordx4 v[16:19], v2, s[8:11], s38 offen
  s_add_u32 s38, s38, 98304
  buffer_load_dwordx4 v[20:23], v2, s[8:11], s38 offen
  s_add_u32 s38, s38, 98304
  buffer_load_dwordx4 v[24:27], v2, s[8:11], s38 offen
  s_add_u32 s38, s38, 98304
  buffer_load_dwordx4 v[28:31], v2, s[8:11], s38 offen
  s_add_u32 s38, s38, 98304
  buffer_load_dwordx4 v[32:35], v2, s[8:11], s38 offen
  s_add_u32 s38, s38, 98304
  buffer_load_dwordx4 v[36:39], v2, s[8:11], s38 offen
  s_add_u32 s38, s38, 98304
  buffer_load_dwordx4 v[40:43], v2, s[8:11], s38 offen
  s_add_u32 s38, s38, 98304
  buffer_load_dwordx4 v[44:47], v2, s[8:11], s38 offen
  s_add_u32 s38, s38, 98304
  buffer_load_dwordx4 v[48:51], v2, s[8:11], s38 offen
  s_add_u32 s38, s38, 98304
  buffer_load_dwordx4 v[52:55], v2, s[8:11], s38 offen
  s_add_u32 s38, s38, 98304
  buffer_load_dwordx4 v[56:59], v2, s[8:11], s38 offen
  s_add_u32 s38, s38, 98304
  buffer_load_dwordx4 v[60:63], v2, s[8:11], s38 offen
  s_add_u32 s38, s38, 98304
  buffer_load_dwordx4 v[64:67], v2, s[8:11], s38 offen
  s_add_u32 s38, s38, 98304
  buffer_load_dwordx4 v[68:71], v2, s[8:11], s38 offen
  s_add_u32 s38, s38, 98304
  buffer_load_dwordx4 v[72:75], v2, s[8:11], s38 offen
  s_add_u32 s38, s38, 98304
  buffer_load_dwordx4 v[76:79], v2, s[8:11], s38 offen
  s_add_u32 s38, s38, 98304
  buffer_load_dwordx4 v[80:83], v2, s[8:11], s38 offen
  s_add_u32 s38, s38, 98304
  buffer_load_dwordx4 v[84:87], v2, s[8:11], s38 offen
  s_add_u32 s38, s38, 98304
  buffer_load_dwordx4 v[88:91], v2, s[8:11], s38 offen
  s_add_u32 s38, s38, 98304
  buffer_load_dwordx4 v[92:95], v2, s[8:11], s38 offen
  s_add_u32 s38, s38, 98304
  v_mov_b32 v8, 0
  v_mov_b32 v9, 0
  v_mov_b32 v10, 0
  v_mov_b32 v11, 0
  v_mov_b32 v12, 0
  v_mov_b32 v13, 0
  v_mov_b32 v14, 0
  v_mov_b32 v15, 0
  s_waitcnt vmcnt(19)
  v_lshlrev_b32 v4, 16, v16
  v_and_b32 v5, s54, v16
  v_pk_add_f32 v[8:9], v[8:9], v[4:5]
  v_lshlrev_b32 v4, 16, v17
  v_and_b32 v5, s54, v17
  v_pk_add_f32 v[10:11], v[10:11], v[4:5]
  v_lshlrev_b32 v4, 16, v18
  v_and_b32 v5, s54, v18
  v_pk_add_f32 v[12:13], v[12:13], v[4:5]
  v_lshlrev_b32 v4, 16, v19
  v_and_b32 v5, s54, v19
  v_pk_add_f32 v[14:15], v[14:15], v[4:5]
  s_waitcnt vmcnt(18)
  v_lshlrev_b32 v4, 16, v20
  v_and_b32 v5, s54, v20
  v_pk_add_f32 v[8:9], v[8:9], v[4:5]
  v_lshlrev_b32 v4, 16, v21
  v_and_b32 v5, s54, v21
  v_pk_add_f32 v[10:11], v[10:11], v[4:5]
  v_lshlrev_b32 v4, 16, v22
  v_and_b32 v5, s54, v22
  v_pk_add_f32 v[12:13], v[12:13], v[4:5]
  v_lshlrev_b32 v4, 16, v23
  v_and_b32 v5, s54, v23
  v_pk_add_f32 v[14:15], v[14:15], v[4:5]
  s_waitcnt vmcnt(17)
  v_lshlrev_b32 v4, 16, v24
  v_and_b32 v5, s54, v24
  v_pk_add_f32 v[8:9], v[8:9], v[4:5]
  v_lshlrev_b32 v4, 16, v25
  v_and_b32 v5, s54, v25
  v_pk_add_f32 v[10:11], v[10:11], v[4:5]
  v_lshlrev_b32 v4, 16, v26
  v_and_b32 v5, s54, v26
  v_pk_add_f32 v[12:13], v[12:13], v[4:5]
  v_lshlrev_b32 v4, 16, v27
  v_and_b32 v5, s54, v27
  v_pk_add_f32 v[14:15], v[14:15], v[4:5]
  s_waitcnt vmcnt(16)
  v_lshlrev_b32 v4, 16, v28
  v_and_b32 v5, s54, v28
  v_pk_add_f32 v[8:9], v[8:9], v[4:5]
  v_lshlrev_b32 v4, 16, v29
  v_and_b32 v5, s54, v29
  v_pk_add_f32 v[10:11], v[10:11], v[4:5]
  v_lshlrev_b32 v4, 16, v30
  v_and_b32 v5, s54, v30
  v_pk_add_f32 v[12:13], v[12:13], v[4:5]
  v_lshlrev_b32 v4, 16, v31
  v_and_b32 v5, s54, v31
  v_pk_add_f32 v[14:15], v[14:15], v[4:5]
  s_waitcnt vmcnt(15)
  v_lshlrev_b32 v4, 16, v32
  v_and_b32 v5, s54, v32
  v_pk_add_f32 v[8:9], v[8:9], v[4:5]
  v_lshlrev_b32 v4, 16, v33
  v_and_b32 v5, s54, v33
  v_pk_add_f32 v[10:11], v[10:11], v[4:5]
  v_lshlrev_b32 v4, 16, v34
  v_and_b32 v5, s54, v34
  v_pk_add_f32 v[12:13], v[12:13], v[4:5]
  v_lshlrev_b32 v4, 16, v35
  v_and_b32 v5, s54, v35
  v_pk_add_f32 v[14:15], v[14:15], v[4:5]
  s_waitcnt vmcnt(14)
  v_lshlrev_b32 v4, 16, v36
  v_and_b32 v5, s54, v36
  v_pk_add_f32 v[8:9], v[8:9], v[4:5]
  v_lshlrev_b32 v4, 16, v37
  v_and_b32 v5, s54, v37
  v_pk_add_f32 v[10:11], v[10:11], v[4:5]
  v_lshlrev_b32 v4, 16, v38
  v_and_b32 v5, s54, v38
  v_pk_add_f32 v[12:13], v[12:13], v[4:5]
  v_lshlrev_b32 v4, 16, v39
  v_and_b32 v5, s54, v39
  v_pk_add_f32 v[14:15], v[14:15], v[4:5]
  s_waitcnt vmcnt(13)
  v_lshlrev_b32 v4, 16, v40
  v_and_b32 v5, s54, v40
  v_pk_add_f32 v[8:9], v[8:9], v[4:5]
  v_lshlrev_b32 v4, 16, v41
  v_and_b32 v5, s54, v41
  v_pk_add_f32 v[10:11], v[10:11], v[4:5]
  v_lshlrev_b32 v4, 16, v42
  v_and_b32 v5, s54, v42
  v_pk_add_f32 v[12:13], v[12:13], v[4:5]
  v_lshlrev_b32 v4, 16, v43
  v_and_b32 v5, s54, v43
  v_pk_add_f32 v[14:15], v[14:15], v[4:5]
  s_waitcnt vmcnt(12)
  v_lshlrev_b32 v4, 16, v44
  v_and_b32 v5, s54, v44
  v_pk_add_f32 v[8:9], v[8:9], v[4:5]
  v_lshlrev_b32 v4, 16, v45
  v_and_b32 v5, s54, v45
  v_pk_add_f32 v[10:11], v[10:11], v[4:5]
  v_lshlrev_b32 v4, 16, v46
  v_and_b32 v5, s54, v46
  v_pk_add_f32 v[12:13], v[12:13], v[4:5]
  v_lshlrev_b32 v4, 16, v47
  v_and_b32 v5, s54, v47
  v_pk_add_f32 v[14:15], v[14:15], v[4:5]
  s_waitcnt vmcnt(11)
  v_lshlrev_b32 v4, 16, v48
  v_and_b32 v5, s54, v48
  v_pk_add_f32 v[8:9], v[8:9], v[4:5]
  v_lshlrev_b32 v4, 16, v49
  v_and_b32 v5, s54, v49
  v_pk_add_f32 v[10:11], v[10:11], v[4:5]
  v_lshlrev_b32 v4, 16, v50
  v_and_b32 v5, s54, v50
  v_pk_add_f32 v[12:13], v[12:13], v[4:5]
  v_lshlrev_b32 v4, 16, v51
  v_and_b32 v5, s54, v51
  v_pk_add_f32 v[14:15], v[14:15], v[4:5]
  s_waitcnt vmcnt(10)
  v_lshlrev_b32 v4, 16, v52
  v_and_b32 v5, s54, v52
  v_pk_add_f32 v[8:9], v[8:9], v[4:5]
  v_lshlrev_b32 v4, 16, v53
  v_and_b32 v5, s54, v53
  v_pk_add_f32 v[10:11], v[10:11], v[4:5]
  v_lshlrev_b32 v4, 16, v54
  v_and_b32 v5, s54, v54
  v_pk_add_f32 v[12:13], v[12:13], v[4:5]
  v_lshlrev_b32 v4, 16, v55
  v_and_b32 v5, s54, v55
  v_pk_add_f32 v[14:15], v[14:15], v[4:5]
  s_waitcnt vmcnt(9)
  v_lshlrev_b32 v4, 16, v56
  v_and_b32 v5, s54, v56
  v_pk_add_f32 v[8:9], v[8:9], v[4:5]
  v_lshlrev_b32 v4, 16, v57
  v_and_b32 v5, s54, v57
  v_pk_add_f32 v[10:11], v[10:11], v[4:5]
  v_lshlrev_b32 v4, 16, v58
  v_and_b32 v5, s54, v58
  v_pk_add_f32 v[12:13], v[12:13], v[4:5]
  v_lshlrev_b32 v4, 16, v59
  v_and_b32 v5, s54, v59
  v_pk_add_f32 v[14:15], v[14:15], v[4:5]
  s_waitcnt vmcnt(8)
  v_lshlrev_b32 v4, 16, v60
  v_and_b32 v5, s54, v60
  v_pk_add_f32 v[8:9], v[8:9], v[4:5]
  v_lshlrev_b32 v4, 16, v61
  v_and_b32 v5, s54, v61
  v_pk_add_f32 v[10:11], v[10:11], v[4:5]
  v_lshlrev_b32 v4, 16, v62
  v_and_b32 v5, s54, v62
  v_pk_add_f32 v[12:13], v[12:13], v[4:5]
  v_lshlrev_b32 v4, 16, v63
  v_and_b32 v5, s54, v63
  v_pk_add_f32 v[14:15], v[14:15], v[4:5]
  s_waitcnt vmcnt(7)
  v_lshlrev_b32 v4, 16, v64
  v_and_b32 v5, s54, v64
  v_pk_add_f32 v[8:9], v[8:9], v[4:5]
  v_lshlrev_b32 v4, 16, v65
  v_and_b32 v5, s54, v65
  v_pk_add_f32 v[10:11], v[10:11], v[4:5]
  v_lshlrev_b32 v4, 16, v66
  v_and_b32 v5, s54, v66
  v_pk_add_f32 v[12:13], v[12:13], v[4:5]
  v_lshlrev_b32 v4, 16, v67
  v_and_b32 v5, s54, v67
  v_pk_add_f32 v[14:15], v[14:15], v[4:5]
  s_waitcnt vmcnt(6)
  v_lshlrev_b32 v4, 16, v68
  v_and_b32 v5, s54, v68
  v_pk_add_f32 v[8:9], v[8:9], v[4:5]
  v_lshlrev_b32 v4, 16, v69
  v_and_b32 v5, s54, v69
  v_pk_add_f32 v[10:11], v[10:11], v[4:5]
  v_lshlrev_b32 v4, 16, v70
  v_and_b32 v5, s54, v70
  v_pk_add_f32 v[12:13], v[12:13], v[4:5]
  v_lshlrev_b32 v4, 16, v71
  v_and_b32 v5, s54, v71
  v_pk_add_f32 v[14:15], v[14:15], v[4:5]
  s_waitcnt vmcnt(5)
  v_lshlrev_b32 v4, 16, v72
  v_and_b32 v5, s54, v72
  v_pk_add_f32 v[8:9], v[8:9], v[4:5]
  v_lshlrev_b32 v4, 16, v73
  v_and_b32 v5, s54, v73
  v_pk_add_f32 v[10:11], v[10:11], v[4:5]
  v_lshlrev_b32 v4, 16, v74
  v_and_b32 v5, s54, v74
  v_pk_add_f32 v[12:13], v[12:13], v[4:5]
  v_lshlrev_b32 v4, 16, v75
  v_and_b32 v5, s54, v75
  v_pk_add_f32 v[14:15], v[14:15], v[4:5]
  s_waitcnt vmcnt(4)
  v_lshlrev_b32 v4, 16, v76
  v_and_b32 v5, s54, v76
  v_pk_add_f32 v[8:9], v[8:9], v[4:5]
  v_lshlrev_b32 v4, 16, v77
  v_and_b32 v5, s54, v77
  v_pk_add_f32 v[10:11], v[10:11], v[4:5]
  v_lshlrev_b32 v4, 16, v78
  v_and_b32 v5, s54, v78
  v_pk_add_f32 v[12:13], v[12:13], v[4:5]
  v_lshlrev_b32 v4, 16, v79
  v_and_b32 v5, s54, v79
  v_pk_add_f32 v[14:15], v[14:15], v[4:5]
  s_waitcnt vmcnt(3)
  v_lshlrev_b32 v4, 16, v80
  v_and_b32 v5, s54, v80
  v_pk_add_f32 v[8:9], v[8:9], v[4:5]
  v_lshlrev_b32 v4, 16, v81
  v_and_b32 v5, s54, v81
  v_pk_add_f32 v[10:11], v[10:11], v[4:5]
  v_lshlrev_b32 v4, 16, v82
  v_and_b32 v5, s54, v82
  v_pk_add_f32 v[12:13], v[12:13], v[4:5]
  v_lshlrev_b32 v4, 16, v83
  v_and_b32 v5, s54, v83
  v_pk_add_f32 v[14:15], v[14:15], v[4:5]
  s_waitcnt vmcnt(2)
  v_lshlrev_b32 v4, 16, v84
  v_and_b32 v5, s54, v84
  v_pk_add_f32 v[8:9], v[8:9], v[4:5]
  v_lshlrev_b32 v4, 16, v85
  v_and_b32 v5, s54, v85
  v_pk_add_f32 v[10:11], v[10:11], v[4:5]
  v_lshlrev_b32 v4, 16, v86
  v_and_b32 v5, s54, v86
  v_pk_add_f32 v[12:13], v[12:13], v[4:5]
  v_lshlrev_b32 v4, 16, v87
  v_and_b32 v5, s54, v87
  v_pk_add_f32 v[14:15], v[14:15], v[4:5]
  s_waitcnt vmcnt(1)
  v_lshlrev_b32 v4, 16, v88
  v_and_b32 v5, s54, v88
  v_pk_add_f32 v[8:9], v[8:9], v[4:5]
  v_lshlrev_b32 v4, 16, v89
  v_and_b32 v5, s54, v89
  v_pk_add_f32 v[10:11], v[10:11], v[4:5]
  v_lshlrev_b32 v4, 16, v90
  v_and_b32 v5, s54, v90
  v_pk_add_f32 v[12:13], v[12:13], v[4:5]
  v_lshlrev_b32 v4, 16, v91
  v_and_b32 v5, s54, v91
  v_pk_add_f32 v[14:15], v[14:15], v[4:5]
  s_waitcnt vmcnt(0)
  v_lshlrev_b32 v4, 16, v92
  v_and_b32 v5, s54, v92
  v_pk_add_f32 v[8:9], v[8:9], v[4:5]
  v_lshlrev_b32 v4, 16, v93
  v_and_b32 v5, s54, v93
  v_pk_add_f32 v[10:11], v[10:11], v[4:5]
  v_lshlrev_b32 v4, 16, v94
  v_and_b32 v5, s54, v94
  v_pk_add_f32 v[12:13], v[12:13], v[4:5]
  v_lshlrev_b32 v4, 16, v95
  v_and_b32 v5, s54, v95
  v_pk_add_f32 v[14:15], v[14:15], v[4:5]
  v_lshlrev_b32 v3, 3, v1
  ds_write_b128 v3, v[8:11]
  ds_write_b128 v3, v[12:15] offset:16
  s_waitcnt lgkmcnt(0)
  s_barrier
  s_cmp_ge_u32 s60, 2
  s_cbranch_scc1 P_cse
  ds_read_b32 v16, v1 offset:0
  ds_read_b32 v17, v1 offset:512
  ds_read_b32 v18, v1 offset:1024
  ds_read_b32 v19, v1 offset:1536
  ds_read_b32 v20, v1 offset:2048
  ds_read_b32 v21, v1 offset:2560
  ds_read_b32 v22, v1 offset:3072
  ds_read_b32 v23, v1 offset:3584
  s_waitcnt lgkmcnt(8)
  ds_read_b32 v24, v1 offset:4096
  ds_read_b32 v25, v1 offset:4608
  ds_read_b32 v26, v1 offset:5120
  ds_read_b32 v27, v1 offset:5632
  ds_read_b32 v28, v1 offset:6144
  ds_read_b32 v29, v1 offset:6656
  ds_read_b32 v30, v1 offset:7168
  ds_read_b32 v31, v1 offset:7680
  s_waitcnt lgkmcnt(8)
  ds_read_b32 v32, v1 offset:8192
  ds_read_b32 v33, v1 offset:8704
  ds_read_b32 v34, v1 offset:9216
  ds_read_b32 v35, v1 offset:9728
  ds_read_b32 v36, v1 offset:10240
  ds_read_b32 v37, v1 offset:10752
  ds_read_b32 v38, v1 offset:11264
  ds_read_b32 v39, v1 offset:11776
  s_waitcnt lgkmcnt(8)
  ds_read_b32 v40, v1 offset:12288
  ds_read_b32 v41, v1 offset:12800
  ds_read_b32 v42, v1 offset:13312
  ds_read_b32 v43, v1 offset:13824
  ds_read_b32 v44, v1 offset:14336
  ds_read_b32 v45, v1 offset:14848
  ds_read_b32 v46, v1 offset:15360
  ds_read_b32 v47, v1 offset:15872
  s_waitcnt lgkmcnt(8)
  s_lshl_b32 s38, s37, 9
  s_waitcnt lgkmcnt(0)
  v_pk_add_f32 v[16:17], v[16:17], v[18:19]
  v_pk_add_f32 v[16:17], v[16:17], v[20:21]
  v_pk_add_f32 v[16:17], v[16:17], v[22:23]
  v_pk_add_f32 v[16:17], v[16:17], v[24:25]
  v_pk_add_f32 v[16:17], v[16:17], v[26:27]
  v_pk_add_f32 v[16:17], v[16:17], v[28:29]
  v_pk_add_f32 v[16:17], v[16:17], v[30:31]
  v_pk_add_f32 v[16:17], v[16:17], v[32:33]
  v_pk_add_f32 v[16:17], v[16:17], v[34:35]
  v_pk_add_f32 v[16:17], v[16:17], v[36:37]
  v_pk_add_f32 v[16:17], v[16:17], v[38:39]
  v_pk_add_f32 v[16:17], v[16:17], v[40:41]
  v_pk_add_f32 v[16:17], v[16:17], v[42:43]
  v_pk_add_f32 v[16:17], v[16:17], v[44:45]
  v_pk_add_f32 v[16:17], v[16:17], v[46:47]
  v_add_f32 v4, v16, v17
  buffer_store_dword v4, v1, s[12:15], s38 offen
P_cse:
  s_waitcnt vmcnt(0) lgkmcnt(0)
  s_endpgm
A_end:
  s_waitcnt lgkmcnt(0)
  s_endpgm
.globl kB_kernel
.p2align 8
.type kB_kernel,@function
kB_kernel:
  v_lshrrev_b32 v1, 6, v0
  v_and_b32 v0, 63, v0
  v_readfirstlane_b32 s60, v1
  s_cmp_ge_u32 s2, 160
  s_cbranch_scc1 B_side
  s_load_dwordx2 s[4:5], s[0:1], 104
  s_load_dwordx2 s[6:7], s[0:1], 64
  s_load_dwordx2 s[32:33], s[0:1], 0
  s_and_b32 s36, s60, 3
  s_and_b32 s37, s2, 7
  s_lshr_b32 s38, s2, 3
  s_and_b32 s39, s38, 1
  s_lshl_b32 s37, s37, 1
  s_add_u32 s37, s37, s39
  s_lshr_b32 s38, s38, 1
  s_mul_i32 s40, s37, 128
  s_mul_i32 s41, s38, 64
  s_cmp_lt_u32 s60, 4
  s_cbranch_scc1 B_comp
  v_lshrrev_b32 v1, 3, v0
  s_mul_i32 s44, s36, 32
  s_add_u32 s44, s44, s40
  v_add_u32 v1, s44, v1
  v_mul_u32_u24 v1, 1280, v1
  v_lshrrev_b32 v2, 4, v0
  v_and_b32 v3, 7, v0
  v_xor_b32 v2, v2, v3
  v_lshlrev_b32 v2, 4, v2
  v_xor_b32 v3, 64, v2
  v_add_u32 v8, v1, v2
  v_add_u32 v9, v1, v3
  v_add_u32 v9, 10240, v9
  v_add_u32 v10, 20480, v8
  v_add_u32 v11, 20480, v9
  v_lshrrev_b32 v1, 3, v0
  v_and_b32 v2, 7, v0
  v_and_b32 v3, 2, v1
  v_xor_b32 v2, v2, v3
  s_lshl_b32 s44, s36, 4
  v_add_u32 v1, s44, v1
  v_mul_u32_u24 v1, 1280, v1
  v_lshl_add_u32 v1, v2, 4, v1
  s_lshl_b32 s44, s41, 1
  v_add_u32 v12, s44, v1
  v_add_u32 v13, 10240, v12
  s_mul_i32 s46, s36, 4096
  s_mul_i32 s47, s36, 2048
  s_add_u32 s47, s47, 16384
  s_mov_b32 s48, 0
  s_mov_b32 s49, 0
  s_mov_b32 s50, 0
  s_mov_b32 s52, 0
  s_waitcnt lgkmcnt(0)
  s_add_u32 s8, s4, 0xa00
  s_addc_u32 s9, s5, 0
  s_mov_b32 s10, 0x280000
  s_mov_b32 s11, 0x00020000
  s_mov_b32 s12, s6
  s_mov_b32 s13, s7
  s_mov_b32 s14, 0xc8000
  s_mov_b32 s15, 0x00020000
B_ll:
  s_add_u32 m0, s46, 0
  s_nop 0
  buffer_load_dwordx4 v8, s[8:11], s48 offen lds
  s_add_u32 m0, s46, 1024
  s_nop 0
  buffer_load_dwordx4 v9, s[8:11], s48 offen lds
  s_add_u32 m0, s46, 2048
  s_nop 0
  buffer_load_dwordx4 v10, s[8:11], s48 offen lds
  s_add_u32 m0, s46, 3072
  s_nop 0
  buffer_load_dwordx4 v11, s[8:11], s48 offen lds
  s_add_u32 m0, s47, 0
  s_nop 0
  buffer_load_dwordx4 v12, s[12:15], s49 offen lds
  s_add_u32 m0, s47, 1024
  s_nop 0
  buffer_load_dwordx4 v13, s[12:15], s49 offen lds
  s_add_u32 s52, s52, 1
  s_cmp_eq_u32 s52, 6
  s_cselect_b32 s52, 0, s52
  s_mov_b32 s53, 24576
  s_cselect_b32 s53, -122880, s53
  s_add_u32 s46, s46, s53
  s_add_u32 s47, s47, s53
  s_add_u32 s48, s48, 128
  s_add_u32 s49, s49, 81920
  s_add_u32 s50, s50, 1
  s_cmp_lt_u32 s50, 4
  s_cbranch_scc1 B_ll
  s_waitcnt vmcnt(18)
  s_barrier
  s_cmp_lt_u32 s50, 10
  s_cbranch_scc1 B_ll
  s_waitcnt vmcnt(12)
  s_barrier
  s_waitcnt vmcnt(6)
  s_barrier
  s_waitcnt vmcnt(0)
  s_barrier
  s_waitcnt vmcnt(0)
  s_barrier
  s_load_dwordx2 s[6:7], s[0:1], 80
  s_lshl_b32 s63, s2, 2
  s_add_u32 s63, s63, s36
  s_mul_i32 s63, s63, 3072
  v_lshlrev_b32 v1, 7, v0
  s_mov_b64 exec, 0xffffff
  s_waitcnt lgkmcnt(0)
  s_mov_b32 s12, s6
  s_mov_b32 s13, s7
  s_mov_b32 s14, 0x1e0000
  s_mov_b32 s15, 0x00020000
  buffer_load_dword v2, v1, s[12:15], s63 offen sc1
  s_mov_b64 exec, -1
  s_waitcnt vmcnt(0) lgkmcnt(0)
  s_endpgm
B_comp:
  v_mov_b32 v194, v0
  s_mov_b32 s42, s36
  s_mov_b32 s43, 0
  v_and_b32 v144, 31, v194
  v_lshrrev_b32 v145, 5, v194
  s_mul_i32 s44, s42, 32
  s_add_u32 s44, s44, s40
  v_add_u32 v146, s44, v144
  s_lshl_b32 s45, s43, 6
  s_add_u32 s45, s45, s41
  v_lshl_add_u32 v147, v145, 5, s45
  v_mul_u32_u24 v190, 1280, v146
  v_lshl_add_u32 v190, v147, 1, v190
  v_lshlrev_b32 v191, 3, v146
  v_mul_u32_u24 v192, 80, v146
  s_waitcnt lgkmcnt(0)
  s_add_u32 s16, s4, 0x800000
  s_addc_u32 s17, s5, 0
  s_mov_b32 s18, 0x280000
  s_mov_b32 s19, 0x00020000
  s_add_u32 s24, s4, 0x1500000
  s_addc_u32 s25, s5, 0
  s_mov_b32 s26, 0x28000
  s_mov_b32 s27, 0x00020000
  v_lshrrev_b32 v140, 3, v194
  v_and_b32 v141, 7, v194
  v_xor_b32 v142, v140, v141
  s_mul_i32 s44, s42, 32
  s_add_u32 s44, s44, s40
  v_add_u32 v140, s44, v140
  v_mul_u32_u24 v140, 1280, v140
  s_lshl_b32 s44, s43, 6
  s_add_u32 s44, s44, s41
  v_lshl_add_u32 v199, v142, 3, s44
  v_lshl_add_u32 v196, v199, 1, v140
  s_mul_i32 s45, s36, 4096
  s_add_u32 s45, s45, 147456
  v_lshl_add_u32 v198, v194, 4, s45
  v_lshlrev_b32 v140, 2, v145
  v_xor_b32 v140, v140, v141
  v_lshlrev_b32 v140, 4, v140
  v_lshl_add_u32 v140, v144, 7, v140
  v_add_u32 v197, s45, v140
  s_mov_b32 s80, 0
  s_mov_b32 s81, 10240
  s_mov_b32 s82, 20480
  s_mov_b32 s83, 30720
  s_mov_b32 s20, s32
  s_mov_b32 s21, s33
  s_mov_b32 s22, 0x280000
  s_mov_b32 s23, 0x00020000
  s_add_u32 s28, s4, 0x290000
  s_addc_u32 s29, s5, 0
  s_mov_b32 s30, 0x4000
  s_mov_b32 s31, 0x00020000
  s_add_u32 m0, s45, 0
  s_nop 0
  buffer_load_dwordx4 v196, s[20:23], s80 offen lds
  s_add_u32 m0, s45, 1024
  s_nop 0
  buffer_load_dwordx4 v196, s[20:23], s81 offen lds
  s_add_u32 m0, s45, 2048
  s_nop 0
  buffer_load_dwordx4 v196, s[20:23], s82 offen lds
  s_add_u32 m0, s45, 3072
  s_nop 0
  buffer_load_dwordx4 v196, s[20:23], s83 offen lds
  buffer_load_dwordx2 v[188:189], v191, s[28:31], 0 offen
  v_lshrrev_b32 v140, 1, v144
  v_and_b32 v140, 7, v140
  v_xor_b32 v140, v140, v145
  v_lshlrev_b32 v140, 4, v140
  v_lshl_add_u32 v140, v144, 7, v140
  s_mul_i32 s44, s42, 4096
  v_add_u32 v140, s44, v140
  v_xor_b32 v112, 0, v140
  v_xor_b32 v113, 32, v140
  v_xor_b32 v114, 64, v140
  v_xor_b32 v115, 96, v140
  v_bfe_u32 v140, v194, 2, 2
  v_lshl_add_u32 v141, v145, 3, v140
  v_mul_u32_u24 v141, 128, v141
  v_and_b32 v142, 1, v194
  v_lshlrev_b32 v142, 6, v142
  v_bfe_u32 v143, v194, 1, 1
  v_lshl_or_b32 v142, v143, 3, v142
  v_bfe_u32 v143, v194, 4, 1
  v_lshl_or_b32 v142, v143, 4, v142
  v_and_b32 v143, 2, v140
  v_lshlrev_b32 v143, 4, v143
  v_xor_b32 v142, v142, v143
  v_add_u32 v141, v141, v142
  v_add_u32 v141, 16384, v141
  v_mov_b32 v116, v141
  v_xor_b32 v117, 32, v141
  s_mov_b64 exec, 0
  s_mov_b32 s50, 10
  s_cmp_eq_u32 s36, 1
  s_cbranch_scc1 B_q1
  s_cmp_eq_u32 s36, 2
  s_cbranch_scc1 B_q2
  s_cmp_eq_u32 s36, 3
  s_cbranch_scc1 B_q3
  s_branch B_loop
B_real:
  s_mov_b64 exec, -1
  s_mov_b32 s61, -98304
  s_mov_b32 s62, 49152
  s_nop 7
  s_nop 7
  v_mov_b32 v0, 0
  v_mov_b32 v1, 0
  v_mov_b32 v2, 0
  v_mov_b32 v3, 0
  v_mov_b32 v4, 0
  v_mov_b32 v5, 0
  v_mov_b32 v6, 0
  v_mov_b32 v7, 0
  v_mov_b32 v8, 0
  v_mov_b32 v9, 0
  v_mov_b32 v10, 0
  v_mov_b32 v11, 0
  v_mov_b32 v12, 0
  v_mov_b32 v13, 0
  v_mov_b32 v14, 0
  v_mov_b32 v15, 0
  v_mov_b32 v16, 0
  v_mov_b32 v17, 0
  v_mov_b32 v18, 0
  v_mov_b32 v19, 0
  v_mov_b32 v20, 0
  v_mov_b32 v21, 0
  v_mov_b32 v22, 0
  v_mov_b32 v23, 0
  v_mov_b32 v24, 0
  v_mov_b32 v25, 0
  v_mov_b32 v26, 0
  v_mov_b32 v27, 0
  v_mov_b32 v28, 0
  v_mov_b32 v29, 0
  v_mov_b32 v30, 0
  v_mov_b32 v31, 0
  s_mov_b32 s50, 0
  s_mov_b32 s51, 0
  s_waitcnt lgkmcnt(0)
  s_barrier
  ds_read_b128 v[64:67], v112 offset:0
  ds_read_b64_tr_b16 v[68:69], v116 offset:0
  ds_read_b64_tr_b16 v[70:71], v116 offset:512
  ds_read_b64_tr_b16 v[72:73], v117 offset:0
  ds_read_b64_tr_b16 v[74:75], v117 offset:512
  ds_read_b128 v[76:79], v113 offset:0
  ds_read_b64_tr_b16 v[80:81], v116 offset:2048
  ds_read_b64_tr_b16 v[82:83], v116 offset:2560
  ds_read_b64_tr_b16 v[84:85], v117 offset:2048
  ds_read_b64_tr_b16 v[86:87], v117 offset:2560
  ds_read_b128 v[88:91], v114 offset:0
  ds_read_b64_tr_b16 v[92:93], v116 offset:4096
  ds_read_b64_tr_b16 v[94:95], v116 offset:4608
  ds_read_b64_tr_b16 v[96:97], v117 offset:4096
  ds_read_b64_tr_b16 v[98:99], v117 offset:4608
B_loop:
  s_waitcnt lgkmcnt(10)
  v_mfma_f32_32x32x16_bf16 v[0:15], v[68:71], v[64:67], v[0:15]
  ds_read_b128 v[100:103], v115 offset:0
  s_add_u32 s51, s51, 2
  ds_read_b64_tr_b16 v[104:105], v116 offset:6144
  s_cmp_eq_u32 s51, 6
  v_mfma_f32_32x32x16_bf16 v[16:31], v[72:75], v[64:67], v[16:31]
  ds_read_b64_tr_b16 v[106:107], v116 offset:6656
  s_cselect_b32 s51, 0, s51
  ds_read_b64_tr_b16 v[108:109], v117 offset:6144
  s_cselect_b32 s53, s61, s62
  ds_read_b64_tr_b16 v[110:111], v117 offset:6656
  s_waitcnt lgkmcnt(10)
  v_mfma_f32_32x32x16_bf16 v[0:15], v[80:83], v[76:79], v[0:15]
  s_cbranch_execz B_g1
  s_barrier
B_g1:
  ds_read_b128 v[64:67], v112 offset:24576
  ds_read_b64_tr_b16 v[68:69], v116 offset:24576
  v_mfma_f32_32x32x16_bf16 v[16:31], v[84:87], v[76:79], v[16:31]
  ds_read_b64_tr_b16 v[70:71], v116 offset:25088
  ds_read_b64_tr_b16 v[72:73], v117 offset:24576
  ds_read_b64_tr_b16 v[74:75], v117 offset:25088
  s_waitcnt lgkmcnt(10)
  v_mfma_f32_32x32x16_bf16 v[0:15], v[92:95], v[88:91], v[0:15]
  ds_read_b128 v[76:79], v113 offset:24576
  ds_read_b64_tr_b16 v[80:81], v116 offset:26624
  v_mfma_f32_32x32x16_bf16 v[16:31], v[96:99], v[88:91], v[16:31]
  ds_read_b64_tr_b16 v[82:83], v116 offset:27136
  ds_read_b64_tr_b16 v[84:85], v117 offset:26624
  ds_read_b64_tr_b16 v[86:87], v117 offset:27136
  s_waitcnt lgkmcnt(10)
  v_mfma_f32_32x32x16_bf16 v[0:15], v[104:107], v[100:103], v[0:15]
  ds_read_b128 v[88:91], v114 offset:24576
  ds_read_b64_tr_b16 v[92:93], v116 offset:28672
  v_mfma_f32_32x32x16_bf16 v[16:31], v[108:111], v[100:103], v[16:31]
  ds_read_b64_tr_b16 v[94:95], v116 offset:29184
  ds_read_b64_tr_b16 v[96:97], v117 offset:28672
  ds_read_b64_tr_b16 v[98:99], v117 offset:29184
  s_waitcnt lgkmcnt(10)
  v_mfma_f32_32x32x16_bf16 v[0:15], v[68:71], v[64:67], v[0:15]
  ds_read_b128 v[100:103], v115 offset:24576
  ds_read_b64_tr_b16 v[104:105], v116 offset:30720
  ds_read_b64_tr_b16 v[106:107], v116 offset:31232
  ds_read_b64_tr_b16 v[108:109], v117 offset:30720
  v_mfma_f32_32x32x16_bf16 v[16:31], v[72:75], v[64:67], v[16:31]
  ds_read_b64_tr_b16 v[110:111], v117 offset:31232
  v_add_u32 v115, s53, v115
  v_add_u32 v116, s53, v116
  v_add_u32 v117, s53, v117
  s_waitcnt lgkmcnt(10)
  v_mfma_f32_32x32x16_bf16 v[0:15], v[80:83], v[76:79], v[0:15]
  s_cbranch_execz B_g2
  s_barrier
B_g2:
  v_add_u32 v112, s53, v112
  ds_read_b128 v[64:67], v112 offset:0
  v_mfma_f32_32x32x16_bf16 v[16:31], v[84:87], v[76:79], v[16:31]
  ds_read_b64_tr_b16 v[68:69], v116 offset:0
  ds_read_b64_tr_b16 v[70:71], v116 offset:512
  ds_read_b64_tr_b16 v[72:73], v117 offset:0
  ds_read_b64_tr_b16 v[74:75], v117 offset:512
  s_waitcnt lgkmcnt(10)
  v_mfma_f32_32x32x16_bf16 v[0:15], v[92:95], v[88:91], v[0:15]
  v_add_u32 v113, s53, v113
  ds_read_b128 v[76:79], v113 offset:0
  ds_read_b64_tr_b16 v[80:81], v116 offset:2048
  v_mfma_f32_32x32x16_bf16 v[16:31], v[96:99], v[88:91], v[16:31]
  ds_read_b64_tr_b16 v[82:83], v116 offset:2560
  ds_read_b64_tr_b16 v[84:85], v117 offset:2048
  ds_read_b64_tr_b16 v[86:87], v117 offset:2560
  s_add_u32 s50, s50, 2
  s_waitcnt lgkmcnt(10)
  v_mfma_f32_32x32x16_bf16 v[0:15], v[104:107], v[100:103], v[0:15]
  v_add_u32 v114, s53, v114
  ds_read_b128 v[88:91], v114 offset:0
  ds_read_b64_tr_b16 v[92:93], v116 offset:4096
  v_mfma_f32_32x32x16_bf16 v[16:31], v[108:111], v[100:103], v[16:31]
  ds_read_b64_tr_b16 v[94:95], v116 offset:4608
  ds_read_b64_tr_b16 v[96:97], v117 offset:4096
  ds_read_b64_tr_b16 v[98:99], v117 offset:4608
  s_cmp_lt_u32 s50, 10
  s_cbranch_scc1 B_loop
  s_cbranch_execz B_real
B_q1:
  s_waitcnt lgkmcnt(0)
  s_cbranch_execz B_g3
  s_waitcnt vmcnt(0)
B_g3:
  s_waitcnt lgkmcnt(6)
  v_xor_b32 v112, 0, v197
  ds_read_b128 v[156:159], v112
  v_xor_b32 v113, 16, v197
  ds_read_b128 v[160:163], v113
  v_xor_b32 v114, 32, v197
  ds_read_b128 v[164:167], v114
  v_xor_b32 v115, 48, v197
  ds_read_b128 v[168:171], v115
  v_mul_f32 v188, v188, v189
  v_sub_f32 v188, 0, v188
  s_mov_b32 s54, 0xffff0000
  v_mov_b32 v124, 0
  v_mov_b32 v125, 0
  v_mov_b32 v126, 0
  v_mov_b32 v127, 0
  s_nop 3
  s_waitcnt lgkmcnt(0)
  v_lshlrev_b32 v72, 16, v156
  v_and_b32 v73, s54, v156
  v_pk_fma_f32 v[72:73], v[72:73], v[188:189], v[188:189] op_sel:[0,1,0] op_sel_hi:[1,1,0]
  v_pk_add_f32 v[0:1], v[0:1], v[72:73]
  v_cvt_pk_bf16_f32 v64, v0, v1
  v_lshlrev_b32 v72, 16, v157
  v_and_b32 v73, s54, v157
  v_pk_fma_f32 v[72:73], v[72:73], v[188:189], v[188:189] op_sel:[0,1,0] op_sel_hi:[1,1,0]
  v_pk_add_f32 v[2:3], v[2:3], v[72:73]
  v_cvt_pk_bf16_f32 v65, v2, v3
  v_lshlrev_b32 v72, 16, v158
  v_and_b32 v73, s54, v158
  v_pk_fma_f32 v[72:73], v[72:73], v[188:189], v[188:189] op_sel:[0,1,0] op_sel_hi:[1,1,0]
  v_pk_add_f32 v[4:5], v[4:5], v[72:73]
  v_cvt_pk_bf16_f32 v66, v4, v5
  v_lshlrev_b32 v72, 16, v159
  v_and_b32 v73, s54, v159
  v_pk_fma_f32 v[72:73], v[72:73], v[188:189], v[188:189] op_sel:[0,1,0] op_sel_hi:[1,1,0]
  v_pk_add_f32 v[6:7], v[6:7], v[72:73]
  v_cvt_pk_bf16_f32 v67, v6, v7
  ds_write_b128 v112, v[64:67]
  s_cbranch_execz B_real
B_q2:
  v_lshlrev_b32 v72, 16, v160
  v_and_b32 v73, s54, v160
  v_pk_fma_f32 v[72:73], v[72:73], v[188:189], v[188:189] op_sel:[0,1,0] op_sel_hi:[1,1,0]
  v_pk_add_f32 v[8:9], v[8:9], v[72:73]
  v_cvt_pk_bf16_f32 v68, v8, v9
  v_lshlrev_b32 v72, 16, v161
  v_and_b32 v73, s54, v161
  v_pk_fma_f32 v[72:73], v[72:73], v[188:189], v[188:189] op_sel:[0,1,0] op_sel_hi:[1,1,0]
  v_pk_add_f32 v[10:11], v[10:11], v[72:73]
  v_cvt_pk_bf16_f32 v69, v10, v11
  v_lshlrev_b32 v72, 16, v162
  v_and_b32 v73, s54, v162
  v_pk_fma_f32 v[72:73], v[72:73], v[188:189], v[188:189] op_sel:[0,1,0] op_sel_hi:[1,1,0]
  v_pk_add_f32 v[12:13], v[12:13], v[72:73]
  v_cvt_pk_bf16_f32 v70, v12, v13
  v_lshlrev_b32 v72, 16, v163
  v_and_b32 v73, s54, v163
  v_pk_fma_f32 v[72:73], v[72:73], v[188:189], v[188:189] op_sel:[0,1,0] op_sel_hi:[1,1,0]
  v_pk_add_f32 v[14:15], v[14:15], v[72:73]
  v_cvt_pk_bf16_f32 v71, v14, v15
  ds_write_b128 v113, v[68:71]
  v_lshlrev_b32 v72, 16, v164
  v_and_b32 v73, s54, v164
  v_pk_fma_f32 v[72:73], v[72:73], v[188:189], v[188:189] op_sel:[0,1,0] op_sel_hi:[1,1,0]
  v_pk_add_f32 v[16:17], v[16:17], v[72:73]
  v_cvt_pk_bf16_f32 v64, v16, v17
  v_lshlrev_b32 v72, 16, v165
  v_and_b32 v73, s54, v165
  v_pk_fma_f32 v[72:73], v[72:73], v[188:189], v[188:189] op_sel:[0,1,0] op_sel_hi:[1,1,0]
  v_pk_add_f32 v[18:19], v[18:19], v[72:73]
  v_cvt_pk_bf16_f32 v65, v18, v19
  v_lshlrev_b32 v72, 16, v166
  v_and_b32 v73, s54, v166
  v_pk_fma_f32 v[72:73], v[72:73], v[188:189], v[188:189] op_sel:[0,1,0] op_sel_hi:[1,1,0]
  v_pk_add_f32 v[20:21], v[20:21], v[72:73]
  v_cvt_pk_bf16_f32 v66, v20, v21
  v_lshlrev_b32 v72, 16, v167
  v_and_b32 v73, s54, v167
  v_pk_fma_f32 v[72:73], v[72:73], v[188:189], v[188:189] op_sel:[0,1,0] op_sel_hi:[1,1,0]
  v_pk_add_f32 v[22:23], v[22:23], v[72:73]
  v_cvt_pk_bf16_f32 v67, v22, v23
  ds_write_b128 v114, v[64:67]
  s_cbranch_execz B_real
B_q3:
  v_lshlrev_b32 v72, 16, v168
  v_and_b32 v73, s54, v168
  v_pk_fma_f32 v[72:73], v[72:73], v[188:189], v[188:189] op_sel:[0,1,0] op_sel_hi:[1,1,0]
  v_pk_add_f32 v[24:25], v[24:25], v[72:73]
  v_cvt_pk_bf16_f32 v68, v24, v25
  v_lshlrev_b32 v72, 16, v169
  v_and_b32 v73, s54, v169
  v_pk_fma_f32 v[72:73], v[72:73], v[188:189], v[188:189] op_sel:[0,1,0] op_sel_hi:[1,1,0]
  v_pk_add_f32 v[26:27], v[26:27], v[72:73]
  v_cvt_pk_bf16_f32 v69, v26, v27
  v_lshlrev_b32 v72, 16, v170
  v_and_b32 v73, s54, v170
  v_pk_fma_f32 v[72:73], v[72:73], v[188:189], v[188:189] op_sel:[0,1,0] op_sel_hi:[1,1,0]
  v_pk_add_f32 v[28:29], v[28:29], v[72:73]
  v_cvt_pk_bf16_f32 v70, v28, v29
  v_lshlrev_b32 v72, 16, v171
  v_and_b32 v73, s54, v171
  v_pk_fma_f32 v[72:73], v[72:73], v[188:189], v[188:189] op_sel:[0,1,0] op_sel_hi:[1,1,0]
  v_pk_add_f32 v[30:31], v[30:31], v[72:73]
  v_cvt_pk_bf16_f32 v71, v30, v31
  ds_write_b128 v115, v[68:71]
  ds_read_b128 v[156:159], v198 offset:0
  ds_read_b128 v[160:163], v198 offset:1024
  ds_read_b128 v[164:167], v198 offset:2048
  ds_read_b128 v[168:171], v198 offset:3072
  s_waitcnt lgkmcnt(3)
  s_cbranch_execz B_g4
  buffer_store_dwordx4 v[156:159], v196, s[16:19], s80 offen sc0 sc1
B_g4:
  s_waitcnt lgkmcnt(2)
  s_cbranch_execz B_g5
  buffer_store_dwordx4 v[160:163], v196, s[16:19], s81 offen sc0 sc1
B_g5:
  s_waitcnt lgkmcnt(1)
  s_cbranch_execz B_g6
  buffer_store_dwordx4 v[164:167], v196, s[16:19], s82 offen sc0 sc1
B_g6:
  s_waitcnt lgkmcnt(0)
  s_cbranch_execz B_g7
  buffer_store_dwordx4 v[168:171], v196, s[16:19], s83 offen sc0 sc1
B_g7:
  v_pk_add_f32 v[124:125], v[124:125], v[0:1]
  v_pk_fma_f32 v[126:127], v[0:1], v[0:1], v[126:127]
  v_pk_add_f32 v[124:125], v[124:125], v[2:3]
  v_pk_fma_f32 v[126:127], v[2:3], v[2:3], v[126:127]
  v_pk_add_f32 v[124:125], v[124:125], v[4:5]
  v_pk_fma_f32 v[126:127], v[4:5], v[4:5], v[126:127]
  v_pk_add_f32 v[124:125], v[124:125], v[6:7]
  v_pk_fma_f32 v[126:127], v[6:7], v[6:7], v[126:127]
  v_pk_add_f32 v[124:125], v[124:125], v[8:9]
  v_pk_fma_f32 v[126:127], v[8:9], v[8:9], v[126:127]
  v_pk_add_f32 v[124:125], v[124:125], v[10:11]
  v_pk_fma_f32 v[126:127], v[10:11], v[10:11], v[126:127]
  v_pk_add_f32 v[124:125], v[124:125], v[12:13]
  v_pk_fma_f32 v[126:127], v[12:13], v[12:13], v[126:127]
  v_pk_add_f32 v[124:125], v[124:125], v[14:15]
  v_pk_fma_f32 v[126:127], v[14:15], v[14:15], v[126:127]
  v_pk_add_f32 v[124:125], v[124:125], v[16:17]
  v_pk_fma_f32 v[126:127], v[16:17], v[16:17], v[126:127]
  v_pk_add_f32 v[124:125], v[124:125], v[18:19]
  v_pk_fma_f32 v[126:127], v[18:19], v[18:19], v[126:127]
  v_pk_add_f32 v[124:125], v[124:125], v[20:21]
  v_pk_fma_f32 v[126:127], v[20:21], v[20:21], v[126:127]
  v_pk_add_f32 v[124:125], v[124:125], v[22:23]
  v_pk_fma_f32 v[126:127], v[22:23], v[22:23], v[126:127]
  v_pk_add_f32 v[124:125], v[124:125], v[24:25]
  v_pk_fma_f32 v[126:127], v[24:25], v[24:25], v[126:127]
  v_pk_add_f32 v[124:125], v[124:125], v[26:27]
  v_pk_fma_f32 v[126:127], v[26:27], v[26:27], v[126:127]
  v_pk_add_f32 v[124:125], v[124:125], v[28:29]
  v_pk_fma_f32 v[126:127], v[28:29], v[28:29], v[126:127]
  v_pk_add_f32 v[124:125], v[124:125], v[30:31]
  v_pk_fma_f32 v[126:127], v[30:31], v[30:31], v[126:127]
  v_add_f32 v124, v124, v125
  v_add_f32 v126, v126, v127
  v_mov_b32 v125, v124
  v_mov_b32 v127, v126
  s_lshl_b32 s44, s38, 3
  s_nop 0
  v_permlane32_swap_b32 v124, v125
  v_permlane32_swap_b32 v126, v127
  s_nop 1
  v_add_f32 v124, v124, v125
  v_add_f32 v125, v126, v127
  s_cbranch_execz B_g8
  buffer_store_dwordx2 v[124:125], v192, s[24:27], s44 offen
B_g8:
  s_cbranch_execz B_real
  s_waitcnt vmcnt(0) lgkmcnt(0)
  s_endpgm
B_side:
  s_sub_u32 s2, s2, 160
  s_cmp_ge_u32 s2, 96
  s_cbranch_scc1 B_end
  s_load_dwordx2 s[4:5], s[0:1], 104
  s_load_dwordx2 s[6:7], s[0:1], 32
  s_load_dwordx2 s[32:33], s[0:1], 40
  v_mov_b32 v96, v0
  s_and_b32 s36, s60, 3
  s_lshl_b32 s37, s2, 2
  s_add_u32 s37, s37, 0
  s_add_u32 s37, s37, s36
  s_mul_i32 s38, s36, 40192
  s_add_u32 s38, s38, 1024
  v_and_b32 v100, 31, v96
  v_lshrrev_b32 v101, 5, v96
  s_lshl_b32 s39, s37, 12
  s_cmp_lt_u32 s60, 4
  s_cbranch_scc1 B_cc
  v_lshlrev_b32 v102, 7, v100
  v_lshl_add_u32 v102, v101, 6, v102
  v_lshlrev_b32 v103, 2, v96
  v_add_u32 v104, 2703360, v103
  s_mul_i32 s40, s37, 4224
  s_mov_b32 s50, 0
  s_waitcnt lgkmcnt(0)
  s_mov_b32 s8, s6
  s_mov_b32 s9, s7
  s_mov_b32 s10, 0x280000
  s_mov_b32 s11, 0x00020000
  s_add_u32 s12, s4, 0x2a0000
  s_addc_u32 s13, s5, 0
  s_mov_b32 s14, 0x528000
  s_mov_b32 s15, 0x00020000
  s_add_u32 m0, s38, 36096
  s_nop 0
  buffer_load_dwordx4 v102, s[8:11], s39 offen offset:0 lds
  s_add_u32 m0, s38, 37104
  s_nop 0
  buffer_load_dwordx4 v102, s[8:11], s39 offen offset:16 lds
  s_add_u32 m0, s38, 38112
  s_nop 0
  buffer_load_dwordx4 v102, s[8:11], s39 offen offset:32 lds
  s_add_u32 m0, s38, 39120
  s_nop 0
  buffer_load_dwordx4 v102, s[8:11], s39 offen offset:48 lds
  s_add_u32 s38, s38, 8192
  s_add_u32 s40, s40, 2048
B_cll:
  s_add_u32 m0, s38, 8192
  s_add_u32 s42, s40, 2048
  buffer_load_dwordx4 v103, s[12:15], s42 offen lds
  s_add_u32 m0, s38, 25728
  s_add_u32 s50, s50, 1
  buffer_load_dwordx4 v104, s[12:15], s42 offen lds
B_cl1:
  s_mov_b32 m0, s38
  s_nop 0
  buffer_load_dwordx4 v103, s[12:15], s40 offen lds
  s_add_u32 m0, s38, 17536
  s_sub_u32 s38, s38, 1024
  buffer_load_dwordx4 v104, s[12:15], s40 offen lds
  s_sub_u32 s40, s40, 256
  s_cmp_eq_u32 s50, 9
  s_cbranch_scc1 B_cl2
  s_cmp_lg_u32 s50, 5
  s_cbranch_scc1 B_cl3
  s_waitcnt vmcnt(12)
  s_barrier
B_cl3:
  s_cmp_lg_u32 s50, 7
  s_cbranch_scc1 B_cl4
  s_waitcnt vmcnt(12)
  s_barrier
B_cl4:
  s_cmp_lt_u32 s50, 8
  s_cbranch_scc1 B_cll
  s_mov_b32 s50, 9
  s_branch B_cl1
B_cl2:
  s_waitcnt vmcnt(0)
  s_barrier
  s_load_dwordx2 s[6:7], s[0:1], 72
  s_lshr_b32 s63, s2, 3
  s_lshl_b32 s63, s63, 2
  s_add_u32 s63, s63, s36
  v_lshlrev_b32 v1, 7, v0
  s_waitcnt lgkmcnt(0)
  s_lshl_b32 s63, s63, 13
  s_mov_b32 s12, s6
  s_mov_b32 s13, s7
  s_mov_b32 s14, 0x1e0000
  s_mov_b32 s15, 0x00020000
  s_mov_b32 s62, 5
B_wpf:
  s_min_u32 s63, s63, 1957888
  s_sub_u32 s62, s62, 1
  buffer_load_dword v2, v1, s[12:15], s63 offen sc1
  s_add_u32 s63, s63, 393216
  s_cmp_lg_u32 s62, 0
  s_cbranch_scc1 B_wpf
  s_waitcnt vmcnt(0) lgkmcnt(0)
  s_endpgm
B_cc:
  v_bfe_u32 v102, v96, 2, 1
  v_lshlrev_b32 v102, 4, v102
  v_bfe_u32 v103, v96, 3, 2
  v_lshl_add_u32 v102, v103, 2, v102
  v_and_b32 v103, 3, v96
  v_add_u32 v102, v102, v103
  v_lshl_add_u32 v102, v101, 5, v102
  v_and_b32 v103, 1, v102
  v_xor_b32 v103, 1, v103
  v_mul_u32_u24 v103, 17536, v103
  v_lshrrev_b32 v102, 1, v102
  v_sub_u32 v102, 511, v102
  v_lshl_add_u32 v102, v102, 4, v103
  v_add_u32 v97, s38, v102
  v_bfe_u32 v102, v96, 4, 1
  v_and_b32 v103, 15, v96
  v_lshl_add_u32 v103, v103, 1, v102
  v_sub_u32 v104, v103, v101
  v_and_b32 v105, 1, v104
  v_ashrrev_i32 v106, 1, v104
  v_lshl_add_u32 v106, v105, 5, v106
  s_add_u32 s42, s38, 36096
  v_lshl_add_u32 v98, v106, 4, s42
  v_cmp_gt_i32 vcc, 0, v104
  v_lshlrev_b32 v117, 6, v103
  v_lshl_add_u32 v117, v101, 5, v117
  v_lshlrev_b32 v118, 2, v117
  s_add_u32 s42, s38, 8064
  v_sub_u32 v118, s42, v118
  v_bfe_u32 v105, v117, 4, 3
  v_and_b32 v106, 7, v96
  v_xor_b32 v105, v105, v106
  v_and_b32 v117, 0x780, v117
  v_lshl_add_u32 v117, v105, 4, v117
  v_add_u32 v119, s38, v117
  v_xor_b32 v120, 16, v119
  v_lshl_add_u32 v121, v96, 4, s38
  v_lshrrev_b32 v105, 3, v96
  v_xor_b32 v106, v106, v105
  v_lshlrev_b32 v105, 7, v105
  v_lshl_add_u32 v117, v106, 4, v105
  s_lshl_b32 s41, s37, 1
  v_mov_b32 v105, s41
  s_waitcnt lgkmcnt(0)
  s_add_u32 s16, s4, 0x1200000
  s_addc_u32 s17, s5, 0
  s_mov_b32 s18, 0x280000
  s_mov_b32 s19, 0x00020000
  s_mov_b32 s20, s32
  s_mov_b32 s21, s33
  s_mov_b32 s22, 0x500
  s_mov_b32 s23, 0x00020000
  buffer_load_ushort v116, v105, s[20:23], 0 offen
  s_mov_b64 exec, 0
  s_mov_b32 s50, 16
  s_branch B_cl
B_creal:
  s_mov_b64 exec, -1
  v_mov_b32 v0, 0
  v_mov_b32 v1, 0
  v_mov_b32 v2, 0
  v_mov_b32 v3, 0
  v_mov_b32 v4, 0
  v_mov_b32 v5, 0
  v_mov_b32 v6, 0
  v_mov_b32 v7, 0
  v_mov_b32 v8, 0
  v_mov_b32 v9, 0
  v_mov_b32 v10, 0
  v_mov_b32 v11, 0
  v_mov_b32 v12, 0
  v_mov_b32 v13, 0
  v_mov_b32 v14, 0
  v_mov_b32 v15, 0
  v_mov_b32 v16, 0
  v_mov_b32 v17, 0
  v_mov_b32 v18, 0
  v_mov_b32 v19, 0
  v_mov_b32 v20, 0
  v_mov_b32 v21, 0
  v_mov_b32 v22, 0
  v_mov_b32 v23, 0
  v_mov_b32 v24, 0
  v_mov_b32 v25, 0
  v_mov_b32 v26, 0
  v_mov_b32 v27, 0
  v_mov_b32 v28, 0
  v_mov_b32 v29, 0
  v_mov_b32 v30, 0
  v_mov_b32 v31, 0
  s_barrier
  ds_read_b128 v[32:35], v98 offset:0
  ds_read_b128 v[36:39], v98 offset:1024
  ds_read_b128 v[40:43], v98 offset:2048
  ds_read_b128 v[44:47], v98 offset:3072
  ds_read_b128 v[48:51], v97 offset:8192
  ds_read_b128 v[56:59], v98 offset:256
  ds_read_b128 v[52:55], v97 offset:0
  ds_read_b128 v[60:63], v97 offset:8256
  ds_read_b128 v[68:71], v98 offset:1280
  ds_read_b128 v[64:67], v97 offset:64
  ds_read_b128 v[72:75], v97 offset:8320
  ds_read_b128 v[80:83], v98 offset:2304
  ds_read_b128 v[76:79], v97 offset:128
  s_waitcnt lgkmcnt(9)
  v_cndmask_b32 v32, v32, v0, vcc
  v_cndmask_b32 v33, v33, v0, vcc
  v_cndmask_b32 v34, v34, v0, vcc
  v_cndmask_b32 v35, v35, v0, vcc
  v_cndmask_b32 v36, v36, v0, vcc
  v_cndmask_b32 v37, v37, v0, vcc
  v_cndmask_b32 v38, v38, v0, vcc
  v_cndmask_b32 v39, v39, v0, vcc
  v_cndmask_b32 v40, v40, v0, vcc
  v_cndmask_b32 v41, v41, v0, vcc
  v_cndmask_b32 v42, v42, v0, vcc
  v_cndmask_b32 v43, v43, v0, vcc
  v_cndmask_b32 v44, v44, v0, vcc
  v_cndmask_b32 v45, v45, v0, vcc
  v_cndmask_b32 v46, v46, v0, vcc
  v_cndmask_b32 v47, v47, v0, vcc
  s_mov_b32 s50, 0
  s_nop 0
B_cl:
  s_waitcnt lgkmcnt(6)
  v_mfma_f32_32x32x16_bf16 v[0:15], v[48:51], v[32:35], v[0:15]
  ds_read_b128 v[84:87], v97 offset:8384
  v_mfma_f32_32x32x16_bf16 v[16:31], v[52:55], v[32:35], v[16:31]
  ds_read_b128 v[92:95], v98 offset:3328
  s_lshr_b32 s51, 0x22, s50
  s_add_u32 s50, s50, 1
  v_mfma_f32_32x32x16_bf16 v[16:31], v[48:51], v[56:59], v[16:31]
  ds_read_b128 v[88:91], v97 offset:192
  v_add_u32 v97, -512, v97
  v_add_u32 v98, -16, v98
  s_bitcmp0_b32 s51, 0
  s_waitcnt lgkmcnt(6)
  v_mfma_f32_32x32x16_bf16 v[0:15], v[60:63], v[36:39], v[0:15]
  s_cbranch_scc1 B_nb
  s_barrier
B_nb:
  ds_read_b128 v[48:51], v97 offset:8192
  v_mfma_f32_32x32x16_bf16 v[16:31], v[64:67], v[36:39], v[16:31]
  ds_read_b128 v[56:59], v98 offset:256
  v_mov_b32_dpp v32, v32 row_shr:1 row_mask:0xf bank_mask:0xf bound_ctrl:0
  v_mov_b32_dpp v33, v33 row_shr:1 row_mask:0xf bank_mask:0xf bound_ctrl:0
  v_mfma_f32_32x32x16_bf16 v[16:31], v[60:63], v[68:71], v[16:31]
  ds_read_b128 v[52:55], v97 offset:0
  v_mov_b32_dpp v34, v34 row_shr:1 row_mask:0xf bank_mask:0xf bound_ctrl:0
  v_mov_b32_dpp v35, v35 row_shr:1 row_mask:0xf bank_mask:0xf bound_ctrl:0
  s_waitcnt lgkmcnt(6)
  v_mfma_f32_32x32x16_bf16 v[0:15], v[72:75], v[40:43], v[0:15]
  ds_read_b128 v[60:63], v97 offset:8256
  v_mov_b32_dpp v36, v36 row_shr:1 row_mask:0xf bank_mask:0xf bound_ctrl:0
  v_mov_b32_dpp v37, v37 row_shr:1 row_mask:0xf bank_mask:0xf bound_ctrl:0
  v_mfma_f32_32x32x16_bf16 v[16:31], v[76:79], v[40:43], v[16:31]
  ds_read_b128 v[68:71], v98 offset:1280
  v_mov_b32_dpp v38, v38 row_shr:1 row_mask:0xf bank_mask:0xf bound_ctrl:0
  v_mov_b32_dpp v39, v39 row_shr:1 row_mask:0xf bank_mask:0xf bound_ctrl:0
  v_mfma_f32_32x32x16_bf16 v[16:31], v[72:75], v[80:83], v[16:31]
  ds_read_b128 v[64:67], v97 offset:64
  s_cmp_lt_u32 s50, 16
  s_waitcnt lgkmcnt(6)
  v_mfma_f32_32x32x16_bf16 v[0:15], v[84:87], v[44:47], v[0:15]
  ds_read_b128 v[72:75], v97 offset:8320
  v_mov_b32_dpp v40, v40 row_shr:1 row_mask:0xf bank_mask:0xf bound_ctrl:0
  v_mov_b32_dpp v41, v41 row_shr:1 row_mask:0xf bank_mask:0xf bound_ctrl:0
  v_mfma_f32_32x32x16_bf16 v[16:31], v[88:91], v[44:47], v[16:31]
  ds_read_b128 v[80:83], v98 offset:2304
  v_mov_b32_dpp v42, v42 row_shr:1 row_mask:0xf bank_mask:0xf bound_ctrl:0
  v_mov_b32_dpp v43, v43 row_shr:1 row_mask:0xf bank_mask:0xf bound_ctrl:0
  v_mov_b32_dpp v44, v44 row_shr:1 row_mask:0xf bank_mask:0xf bound_ctrl:0
  v_mfma_f32_32x32x16_bf16 v[16:31], v[84:87], v[92:95], v[16:31]
  ds_read_b128 v[76:79], v97 offset:128
  v_mov_b32_dpp v45, v45 row_shr:1 row_mask:0xf bank_mask:0xf bound_ctrl:0
  v_mov_b32_dpp v46, v46 row_shr:1 row_mask:0xf bank_mask:0xf bound_ctrl:0
  v_mov_b32_dpp v47, v47 row_shr:1 row_mask:0xf bank_mask:0xf bound_ctrl:0
  s_cbranch_scc1 B_cl
  s_waitcnt lgkmcnt(0)
  ds_read_b128 v[48:51], v118 offset:8256
  ds_read_b128 v[52:55], v118 offset:8192
  ds_read_b128 v[56:59], v118 offset:64
  ds_read_b128 v[60:63], v118 offset:0
  s_cbranch_execz B_cg
  s_waitcnt vmcnt(0)
B_cg:
  v_lshlrev_b32 v116, 16, v116
  s_mov_b32 s54, 0xffff0000
  s_nop 3
  s_waitcnt lgkmcnt(0)
  v_lshlrev_b32 v100, 16, v48
  v_and_b32 v101, s54, v48
  v_fmac_f32 v7, v100, v116
  v_fmac_f32 v6, v101, v116
  v_lshlrev_b32 v100, 16, v49
  v_and_b32 v101, s54, v49
  v_fmac_f32 v5, v100, v116
  v_fmac_f32 v4, v101, v116
  v_lshlrev_b32 v100, 16, v50
  v_and_b32 v101, s54, v50
  v_fmac_f32 v3, v100, v116
  v_fmac_f32 v2, v101, v116
  v_lshlrev_b32 v100, 16, v51
  v_and_b32 v101, s54, v51
  v_fmac_f32 v1, v100, v116
  v_fmac_f32 v0, v101, v116
  v_cvt_pk_bf16_f32 v32, v0, v1
  v_cvt_pk_bf16_f32 v33, v2, v3
  v_cvt_pk_bf16_f32 v34, v4, v5
  v_cvt_pk_bf16_f32 v35, v6, v7
  ds_write_b128 v119, v[32:35] offset:0
  v_lshlrev_b32 v100, 16, v52
  v_and_b32 v101, s54, v52
  v_fmac_f32 v15, v100, v116
  v_fmac_f32 v14, v101, v116
  v_lshlrev_b32 v100, 16, v53
  v_and_b32 v101, s54, v53
  v_fmac_f32 v13, v100, v116
  v_fmac_f32 v12, v101, v116
  v_lshlrev_b32 v100, 16, v54
  v_and_b32 v101, s54, v54
  v_fmac_f32 v11, v100, v116
  v_fmac_f32 v10, v101, v116
  v_lshlrev_b32 v100, 16, v55
  v_and_b32 v101, s54, v55
  v_fmac_f32 v9, v100, v116
  v_fmac_f32 v8, v101, v116
  v_cvt_pk_bf16_f32 v36, v8, v9
  v_cvt_pk_bf16_f32 v37, v10, v11
  v_cvt_pk_bf16_f32 v38, v12, v13
  v_cvt_pk_bf16_f32 v39, v14, v15
  ds_write_b128 v120, v[36:39] offset:0
  v_lshlrev_b32 v100, 16, v56
  v_and_b32 v101, s54, v56
  v_fmac_f32 v23, v100, v116
  v_fmac_f32 v22, v101, v116
  v_lshlrev_b32 v100, 16, v57
  v_and_b32 v101, s54, v57
  v_fmac_f32 v21, v100, v116
  v_fmac_f32 v20, v101, v116
  v_lshlrev_b32 v100, 16, v58
  v_and_b32 v101, s54, v58
  v_fmac_f32 v19, v100, v116
  v_fmac_f32 v18, v101, v116
  v_lshlrev_b32 v100, 16, v59
  v_and_b32 v101, s54, v59
  v_fmac_f32 v17, v100, v116
  v_fmac_f32 v16, v101, v116
  v_cvt_pk_bf16_f32 v40, v16, v17
  v_cvt_pk_bf16_f32 v41, v18, v19
  v_cvt_pk_bf16_f32 v42, v20, v21
  v_cvt_pk_bf16_f32 v43, v22, v23
  ds_write_b128 v119, v[40:43] offset:2048
  v_lshlrev_b32 v100, 16, v60
  v_and_b32 v101, s54, v60
  v_fmac_f32 v31, v100, v116
  v_fmac_f32 v30, v101, v116
  v_lshlrev_b32 v100, 16, v61
  v_and_b32 v101, s54, v61
  v_fmac_f32 v29, v100, v116
  v_fmac_f32 v28, v101, v116
  v_lshlrev_b32 v100, 16, v62
  v_and_b32 v101, s54, v62
  v_fmac_f32 v27, v100, v116
  v_fmac_f32 v26, v101, v116
  v_lshlrev_b32 v100, 16, v63
  v_and_b32 v101, s54, v63
  v_fmac_f32 v25, v100, v116
  v_fmac_f32 v24, v101, v116
  v_cvt_pk_bf16_f32 v44, v24, v25
  v_cvt_pk_bf16_f32 v45, v26, v27
  v_cvt_pk_bf16_f32 v46, v28, v29
  v_cvt_pk_bf16_f32 v47, v30, v31
  ds_write_b128 v120, v[44:47] offset:2048
  ds_read_b128 v[0:3], v121 offset:0
  ds_read_b128 v[4:7], v121 offset:1024
  ds_read_b128 v[8:11], v121 offset:2048
  ds_read_b128 v[12:15], v121 offset:3072
  s_cbranch_execz B_creal
  s_waitcnt lgkmcnt(3)
  buffer_store_dwordx4 v[0:3], v117, s[16:19], s39 offen offset:0 sc0 sc1
  s_waitcnt lgkmcnt(2)
  buffer_store_dwordx4 v[4:7], v117, s[16:19], s39 offen offset:1024 sc0 sc1
  s_waitcnt lgkmcnt(1)
  buffer_store_dwordx4 v[8:11], v117, s[16:19], s39 offen offset:2048 sc0 sc1
  s_waitcnt lgkmcnt(0)
  buffer_store_dwordx4 v[12:15], v117, s[16:19], s39 offen offset:3072 sc0 sc1
  s_waitcnt vmcnt(0) lgkmcnt(0)
  s_endpgm
B_end:
  s_waitcnt lgkmcnt(0)
  s_endpgm
.globl kC_kernel
.p2align 8
.type kC_kernel,@function
kC_kernel:
  v_lshrrev_b32 v1, 6, v0
  v_and_b32 v0, 63, v0
  v_readfirstlane_b32 s60, v1
  s_cmp_ge_u32 s2, 192
  s_cbranch_scc1 C_side
  s_load_dwordx2 s[4:5], s[0:1], 104
  s_load_dwordx2 s[6:7], s[0:1], 72
  s_load_dwordx2 s[32:33], s[0:1], 0
  s_and_b32 s36, s60, 3
  s_and_b32 s37, s2, 7
  s_lshr_b32 s38, s2, 3
  s_and_b32 s39, s38, 1
  s_lshl_b32 s37, s37, 1
  s_add_u32 s37, s37, s39
  s_lshr_b32 s38, s38, 1
  s_mul_i32 s40, s37, 128
  s_mul_i32 s41, s38, 128
  s_cmp_lt_u32 s60, 4
  s_cbranch_scc1 C_comp
  v_lshrrev_b32 v1, 3, v0
  s_mul_i32 s44, s36, 32
  s_add_u32 s44, s44, s40
  v_add_u32 v1, s44, v1
  v_mul_u32_u24 v1, 1280, v1
  v_lshrrev_b32 v2, 4, v0
  v_and_b32 v3, 7, v0
  v_xor_b32 v2, v2, v3
  v_lshlrev_b32 v2, 4, v2
  v_xor_b32 v3, 64, v2
  v_add_u32 v8, v1, v2
  v_add_u32 v9, v1, v3
  v_add_u32 v9, 10240, v9
  v_add_u32 v10, 20480, v8
  v_add_u32 v11, 20480, v9
  v_lshrrev_b32 v1, 4, v0
  v_and_b32 v2, 15, v0
  v_and_b32 v3, 1, v1
  v_lshlrev_b32 v3, 1, v3
  v_and_b32 v4, 2, v1
  v_lshl_or_b32 v3, v4, 2, v3
  v_xor_b32 v2, v2, v3
  s_lshl_b32 s44, s36, 4
  v_add_u32 v1, s44, v1
  v_mul_u32_u24 v1, 3072, v1
  v_lshl_add_u32 v1, v2, 4, v1
  s_lshl_b32 s44, s41, 1
  v_add_u32 v12, s44, v1
  v_add_u32 v13, 12288, v12
  v_add_u32 v14, 24576, v12
  v_add_u32 v15, 36864, v12
  s_mul_i32 s46, s36, 4096
  s_mul_i32 s47, s36, 4096
  s_add_u32 s47, s47, 16384
  s_mov_b32 s48, 0
  s_mov_b32 s49, 0
  s_mov_b32 s50, 0
  s_mov_b32 s52, 0
  s_waitcnt lgkmcnt(0)
  s_add_u32 s8, s4, 0x800000
  s_addc_u32 s9, s5, 0
  s_mov_b32 s10, 0x280000
  s_mov_b32 s11, 0x00020000
  s_mov_b32 s12, s6
  s_mov_b32 s13, s7
  s_mov_b32 s14, 0x1e0000
  s_mov_b32 s15, 0x00020000
C_ll:
  s_add_u32 m0, s46, 0
  s_nop 0
  buffer_load_dwordx4 v8, s[8:11], s48 offen lds
  s_add_u32 m0, s46, 1024
  s_nop 0
  buffer_load_dwordx4 v9, s[8:11], s48 offen lds
  s_add_u32 m0, s46, 2048
  s_nop 0
  buffer_load_dwordx4 v10, s[8:11], s48 offen lds
  s_add_u32 m0, s46, 3072
  s_nop 0
  buffer_load_dwordx4 v11, s[8:11], s48 offen lds
  s_add_u32 m0, s47, 0
  s_nop 0
  buffer_load_dwordx4 v12, s[12:15], s49 offen lds
  s_add_u32 m0, s47, 1024
  s_nop 0
  buffer_load_dwordx4 v13, s[12:15], s49 offen lds
  s_add_u32 m0, s47, 2048
  s_nop 0
  buffer_load_dwordx4 v14, s[12:15], s49 offen lds
  s_add_u32 m0, s47, 3072
  s_nop 0
  buffer_load_dwordx4 v15, s[12:15], s49 offen lds
  s_add_u32 s52, s52, 1
  s_cmp_eq_u32 s52, 5
  s_cselect_b32 s52, 0, s52
  s_mov_b32 s53, 32768
  s_cselect_b32 s53, -131072, s53
  s_add_u32 s46, s46, s53
  s_add_u32 s47, s47, s53
  s_add_u32 s48, s48, 128
  s_add_u32 s49, s49, 196608
  s_add_u32 s50, s50, 1
  s_cmp_lt_u32 s50, 3
  s_cbranch_scc1 C_ll
  s_waitcnt vmcnt(16)
  s_barrier
  s_cmp_lt_u32 s50, 10
  s_cbranch_scc1 C_ll
  s_waitcnt vmcnt(8)
  s_barrier
  s_waitcnt vmcnt(0)
  s_barrier
  s_waitcnt vmcnt(0)
  s_barrier
  s_waitcnt vmcnt(0) lgkmcnt(0)
  s_endpgm
C_comp:
  v_mov_b32 v210, v0
  s_lshr_b32 s42, s36, 1
  s_and_b32 s43, s36, 1
  v_and_b32 v160, 31, v210
  v_lshrrev_b32 v161, 5, v210
  s_mul_i32 s44, s42, 64
  s_add_u32 s44, s44, s40
  v_add_u32 v162, s44, v160
  s_lshl_b32 s45, s43, 6
  s_add_u32 s45, s45, s41
  v_lshl_add_u32 v163, v161, 5, s45
  v_mul_u32_u24 v206, 3072, v162
  v_lshl_add_u32 v206, v163, 1, v206
  v_lshlrev_b32 v207, 3, v162
  v_mul_u32_u24 v208, 80, v162
  s_waitcnt lgkmcnt(0)
  s_add_u32 s16, s4, 0xb00000
  s_addc_u32 s17, s5, 0
  s_mov_b32 s18, 0x600000
  s_mov_b32 s19, 0x00020000
  v_lshrrev_b32 v156, 3, v210
  v_and_b32 v157, 7, v210
  v_xor_b32 v158, v156, v157
  s_mul_i32 s44, s42, 64
  s_add_u32 s44, s44, s40
  v_add_u32 v156, s44, v156
  v_mul_u32_u24 v156, 3072, v156
  s_lshl_b32 s44, s43, 6
  s_add_u32 s44, s44, s41
  v_lshl_add_u32 v239, v158, 3, s44
  v_lshl_add_u32 v236, v239, 1, v156
  s_mul_i32 s45, s36, 4096
  s_add_u32 s45, s45, 0
  v_lshl_add_u32 v238, v210, 4, s45
  v_lshlrev_b32 v156, 2, v161
  v_xor_b32 v156, v156, v157
  v_lshlrev_b32 v156, 4, v156
  v_lshl_add_u32 v156, v160, 7, v156
  v_add_u32 v237, s45, v156
  s_mov_b32 s80, 0
  s_mov_b32 s81, 24576
  s_mov_b32 s82, 49152
  s_mov_b32 s83, 73728
  s_mov_b32 s84, 98304
  s_mov_b32 s85, 122880
  s_mov_b32 s86, 147456
  s_mov_b32 s87, 172032
  s_add_u32 s20, s4, 0x1500000
  s_addc_u32 s21, s5, 0
  s_mov_b32 s22, 0x28000
  s_mov_b32 s23, 0x00020000
  s_add_u32 s24, s4, 0x1540000
  s_addc_u32 s25, s5, 0
  s_mov_b32 s26, 0x1800
  s_mov_b32 s27, 0x00020000
  v_mul_u32_u24 v156, 2560, v161
  v_add_u32 v156, v156, v208
  v_lshlrev_b32 v157, 2, v163
  buffer_load_dwordx4 v[212:215], v156, s[20:23], 0 offen offset:0
  buffer_load_dwordx4 v[216:219], v156, s[20:23], 0 offen offset:16
  buffer_load_dwordx4 v[220:223], v156, s[20:23], 0 offen offset:32
  buffer_load_dwordx4 v[224:227], v156, s[20:23], 0 offen offset:48
  buffer_load_dwordx4 v[228:231], v156, s[20:23], 0 offen offset:64
  buffer_load_dwordx4 v[172:175], v157, s[24:27], 0 offen offset:0
  buffer_load_dwordx4 v[176:179], v157, s[24:27], 0 offen offset:16
  buffer_load_dwordx4 v[180:183], v157, s[24:27], 0 offen offset:32
  buffer_load_dwordx4 v[184:187], v157, s[24:27], 0 offen offset:48
  buffer_load_dwordx4 v[188:191], v157, s[24:27], 0 offen offset:64
  buffer_load_dwordx4 v[192:195], v157, s[24:27], 0 offen offset:80
  buffer_load_dwordx4 v[196:199], v157, s[24:27], 0 offen offset:96
  buffer_load_dwordx4 v[200:203], v157, s[24:27], 0 offen offset:112
  v_lshrrev_b32 v156, 1, v160
  v_and_b32 v156, 7, v156
  v_xor_b32 v156, v156, v161
  v_lshlrev_b32 v156, 4, v156
  v_lshl_add_u32 v156, v160, 7, v156
  s_mul_i32 s44, s42, 8192
  v_add_u32 v156, s44, v156
  v_xor_b32 v128, 0, v156
  v_xor_b32 v129, 32, v156
  v_xor_b32 v130, 64, v156
  v_xor_b32 v131, 96, v156
  v_bfe_u32 v156, v210, 2, 2
  v_lshl_add_u32 v157, v161, 3, v156
  v_mul_u32_u24 v157, 256, v157
  v_and_b32 v158, 1, v210
  v_lshlrev_b32 v158, 6, v158
  v_bfe_u32 v159, v210, 1, 1
  v_lshl_or_b32 v158, v159, 3, v158
  v_bfe_u32 v159, v210, 4, 1
  v_lshl_or_b32 v158, v159, 4, v158
  s_lshl_b32 s44, s43, 7
  v_or_b32 v158, s44, v158
  v_and_b32 v159, 1, v156
  v_lshlrev_b32 v159, 5, v159
  v_and_b32 v156, 2, v156
  v_lshl_or_b32 v159, v156, 6, v159
  v_xor_b32 v158, v158, v159
  v_add_u32 v157, v157, v158
  v_add_u32 v157, 16384, v157
  v_mov_b32 v132, v157
  v_xor_b32 v133, 32, v157
  s_mov_b64 exec, 0
  s_mov_b32 s50, 10
  s_cmp_eq_u32 s36, 1
  s_cbranch_scc1 C_q1
  s_cmp_eq_u32 s36, 2
  s_cbranch_scc1 C_q2
  s_cmp_eq_u32 s36, 3
  s_cbranch_scc1 C_q3
  s_branch C_loop
C_real:
  s_mov_b64 exec, -1
  s_mov_b32 s61, -131072
  s_mov_b32 s62, 32768
  s_nop 7
  s_nop 7
  v_mov_b32 v0, 0
  v_mov_b32 v1, 0
  v_mov_b32 v2, 0
  v_mov_b32 v3, 0
  v_mov_b32 v4, 0
  v_mov_b32 v5, 0
  v_mov_b32 v6, 0
  v_mov_b32 v7, 0
  v_mov_b32 v8, 0
  v_mov_b32 v9, 0
  v_mov_b32 v10, 0
  v_mov_b32 v11, 0
  v_mov_b32 v12, 0
  v_mov_b32 v13, 0
  v_mov_b32 v14, 0
  v_mov_b32 v15, 0
  v_mov_b32 v16, 0
  v_mov_b32 v17, 0
  v_mov_b32 v18, 0
  v_mov_b32 v19, 0
  v_mov_b32 v20, 0
  v_mov_b32 v21, 0
  v_mov_b32 v22, 0
  v_mov_b32 v23, 0
  v_mov_b32 v24, 0
  v_mov_b32 v25, 0
  v_mov_b32 v26, 0
  v_mov_b32 v27, 0
  v_mov_b32 v28, 0
  v_mov_b32 v29, 0
  v_mov_b32 v30, 0
  v_mov_b32 v31, 0
  v_mov_b32 v32, 0
  v_mov_b32 v33, 0
  v_mov_b32 v34, 0
  v_mov_b32 v35, 0
  v_mov_b32 v36, 0
  v_mov_b32 v37, 0
  v_mov_b32 v38, 0
  v_mov_b32 v39, 0
  v_mov_b32 v40, 0
  v_mov_b32 v41, 0
  v_mov_b32 v42, 0
  v_mov_b32 v43, 0
  v_mov_b32 v44, 0
  v_mov_b32 v45, 0
  v_mov_b32 v46, 0
  v_mov_b32 v47, 0
  v_mov_b32 v48, 0
  v_mov_b32 v49, 0
  v_mov_b32 v50, 0
  v_mov_b32 v51, 0
  v_mov_b32 v52, 0
  v_mov_b32 v53, 0
  v_mov_b32 v54, 0
  v_mov_b32 v55, 0
  v_mov_b32 v56, 0
  v_mov_b32 v57, 0
  v_mov_b32 v58, 0
  v_mov_b32 v59, 0
  v_mov_b32 v60, 0
  v_mov_b32 v61, 0
  v_mov_b32 v62, 0
  v_mov_b32 v63, 0
  s_mov_b32 s50, 0
  s_mov_b32 s51, 0
  s_waitcnt lgkmcnt(0)
  s_barrier
  ds_read_b128 v[64:67], v128 offset:0
  ds_read_b128 v[68:71], v128 offset:4096
  ds_read_b64_tr_b16 v[72:73], v132 offset:0
  ds_read_b64_tr_b16 v[74:75], v132 offset:1024
  ds_read_b64_tr_b16 v[76:77], v133 offset:0
  ds_read_b64_tr_b16 v[78:79], v133 offset:1024
  ds_read_b128 v[80:83], v129 offset:0
  ds_read_b128 v[84:87], v129 offset:4096
  ds_read_b64_tr_b16 v[88:89], v132 offset:4096
  ds_read_b64_tr_b16 v[90:91], v132 offset:5120
  ds_read_b64_tr_b16 v[92:93], v133 offset:4096
  ds_read_b64_tr_b16 v[94:95], v133 offset:5120
  ds_read_b128 v[96:99], v130 offset:0
  ds_read_b128 v[100:103], v130 offset:4096
  ds_read_b64_tr_b16 v[104:105], v132 offset:8192
  ds_read_b64_tr_b16 v[106:107], v132 offset:9216
  ds_read_b64_tr_b16 v[108:109], v133 offset:8192
  ds_read_b64_tr_b16 v[110:111], v133 offset:9216
C_loop:
  s_waitcnt lgkmcnt(12)
  v_mfma_f32_32x32x16_bf16 v[0:15], v[72:75], v[64:67], v[0:15]
  ds_read_b128 v[112:115], v131 offset:0
  s_add_u32 s51, s51, 1
  ds_read_b128 v[116:119], v131 offset:4096
  v_mfma_f32_32x32x16_bf16 v[16:31], v[76:79], v[64:67], v[16:31]
  s_cmp_eq_u32 s51, 5
  ds_read_b64_tr_b16 v[120:121], v132 offset:12288
  s_cselect_b32 s51, 0, s51
  v_mfma_f32_32x32x16_bf16 v[32:47], v[72:75], v[68:71], v[32:47]
  ds_read_b64_tr_b16 v[122:123], v132 offset:13312
  s_cselect_b32 s53, s61, s62
  ds_read_b64_tr_b16 v[124:125], v133 offset:12288
  v_mfma_f32_32x32x16_bf16 v[48:63], v[76:79], v[68:71], v[48:63]
  ds_read_b64_tr_b16 v[126:127], v133 offset:13312
  v_add_u32 v131, s53, v131
  v_add_u32 v132, s53, v132
  v_add_u32 v133, s53, v133
  s_waitcnt lgkmcnt(12)
  v_mfma_f32_32x32x16_bf16 v[0:15], v[88:91], v[80:83], v[0:15]
  s_cbranch_execz C_g1
  s_barrier
C_g1:
  v_add_u32 v128, s53, v128
  v_mfma_f32_32x32x16_bf16 v[16:31], v[92:95], v[80:83], v[16:31]
  ds_read_b128 v[64:67], v128 offset:0
  ds_read_b128 v[68:71], v128 offset:4096
  v_mfma_f32_32x32x16_bf16 v[32:47], v[88:91], v[84:87], v[32:47]
  ds_read_b64_tr_b16 v[72:73], v132 offset:0
  ds_read_b64_tr_b16 v[74:75], v132 offset:1024
  v_mfma_f32_32x32x16_bf16 v[48:63], v[92:95], v[84:87], v[48:63]
  ds_read_b64_tr_b16 v[76:77], v133 offset:0
  ds_read_b64_tr_b16 v[78:79], v133 offset:1024
  s_waitcnt lgkmcnt(12)
  v_mfma_f32_32x32x16_bf16 v[0:15], v[104:107], v[96:99], v[0:15]
  v_add_u32 v129, s53, v129
  ds_read_b128 v[80:83], v129 offset:0
  v_mfma_f32_32x32x16_bf16 v[16:31], v[108:111], v[96:99], v[16:31]
  ds_read_b128 v[84:87], v129 offset:4096
  ds_read_b64_tr_b16 v[88:89], v132 offset:4096
  v_mfma_f32_32x32x16_bf16 v[32:47], v[104:107], v[100:103], v[32:47]
  ds_read_b64_tr_b16 v[90:91], v132 offset:5120
  ds_read_b64_tr_b16 v[92:93], v133 offset:4096
  v_mfma_f32_32x32x16_bf16 v[48:63], v[108:111], v[100:103], v[48:63]
  ds_read_b64_tr_b16 v[94:95], v133 offset:5120
  s_add_u32 s50, s50, 1
  s_waitcnt lgkmcnt(12)
  v_mfma_f32_32x32x16_bf16 v[0:15], v[120:123], v[112:115], v[0:15]
  v_add_u32 v130, s53, v130
  ds_read_b128 v[96:99], v130 offset:0
  v_mfma_f32_32x32x16_bf16 v[16:31], v[124:127], v[112:115], v[16:31]
  ds_read_b128 v[100:103], v130 offset:4096
  ds_read_b64_tr_b16 v[104:105], v132 offset:8192
  v_mfma_f32_32x32x16_bf16 v[32:47], v[120:123], v[116:119], v[32:47]
  ds_read_b64_tr_b16 v[106:107], v132 offset:9216
  ds_read_b64_tr_b16 v[108:109], v133 offset:8192
  v_mfma_f32_32x32x16_bf16 v[48:63], v[124:127], v[116:119], v[48:63]
  ds_read_b64_tr_b16 v[110:111], v133 offset:9216
  s_cmp_lt_u32 s50, 10
  s_cbranch_scc1 C_loop
  s_cbranch_execz C_real
C_q1:
  s_waitcnt lgkmcnt(0)
  s_cbranch_execz C_g2
  s_waitcnt vmcnt(0)
C_g2:
  v_pk_add_f32 v[212:213], v[212:213], v[214:215]
  v_pk_add_f32 v[212:213], v[212:213], v[216:217]
  v_pk_add_f32 v[212:213], v[212:213], v[218:219]
  v_pk_add_f32 v[212:213], v[212:213], v[220:221]
  v_pk_add_f32 v[212:213], v[212:213], v[222:223]
  v_pk_add_f32 v[212:213], v[212:213], v[224:225]
  v_pk_add_f32 v[212:213], v[212:213], v[226:227]
  v_pk_add_f32 v[212:213], v[212:213], v[228:229]
  v_pk_add_f32 v[212:213], v[212:213], v[230:231]
  v_mov_b32 v140, v212
  v_mov_b32 v144, v213
  v_mul_f32 v140, 0x3acccccd, v140
  v_mul_f32 v144, 0x3acccccd, v144
  v_fma_f32 v144, -v140, v140, v144
  v_max_f32 v144, 0, v144
  v_add_f32 v160, 0x3727c5ac, v144
  v_rsq_f32 v160, v160
  s_nop 0
  v_mov_b32 v144, v160
  v_mov_b32 v145, v160
  v_mov_b32 v141, v140
  s_nop 1
  v_permlane32_swap_b32 v144, v145
  v_permlane32_swap_b32 v140, v141
  s_nop 1
  s_waitcnt lgkmcnt(0)
  v_sub_f32 v168, 0, v140
  v_rcp_f32 v170, v144
  v_mul_f32 v166, 0xc0135761, v144
  v_mul_f32 v167, v144, v144
  v_mul_f32 v167, v167, v166
  v_mul_f32 v167, 0x3d372713, v167
  s_mov_b32 s56, 0
  v_pk_fma_f32 v[0:1], v[172:173], v[168:169], v[0:1] op_sel_hi:[1,0,1]
  v_pk_fma_f32 v[2:3], v[174:175], v[168:169], v[2:3] op_sel_hi:[1,0,1]
  v_pk_fma_f32 v[4:5], v[176:177], v[168:169], v[4:5] op_sel_hi:[1,0,1]
  v_pk_fma_f32 v[6:7], v[178:179], v[168:169], v[6:7] op_sel_hi:[1,0,1]
  v_pk_mul_f32 v[64:65], v[0:1], v[0:1]
  v_pk_mul_f32 v[66:67], v[2:3], v[2:3]
  v_pk_mul_f32 v[68:69], v[4:5], v[4:5]
  v_pk_mul_f32 v[70:71], v[6:7], v[6:7]
  v_pk_fma_f32 v[64:65], v[64:65], v[166:167], v[166:167] op_sel:[0,1,0] op_sel_hi:[1,1,0]
  v_pk_fma_f32 v[66:67], v[66:67], v[166:167], v[166:167] op_sel:[0,1,0] op_sel_hi:[1,1,0]
  v_pk_fma_f32 v[68:69], v[68:69], v[166:167], v[166:167] op_sel:[0,1,0] op_sel_hi:[1,1,0]
  v_pk_fma_f32 v[70:71], v[70:71], v[166:167], v[166:167] op_sel:[0,1,0] op_sel_hi:[1,1,0]
  v_pk_mul_f32 v[64:65], v[64:65], v[0:1]
  v_pk_mul_f32 v[66:67], v[66:67], v[2:3]
  v_pk_mul_f32 v[68:69], v[68:69], v[4:5]
  v_pk_mul_f32 v[70:71], v[70:71], v[6:7]
  v_exp_f32 v64, v64
  v_exp_f32 v65, v65
  v_exp_f32 v66, v66
  v_exp_f32 v67, v67
  v_exp_f32 v68, v68
  v_exp_f32 v69, v69
  v_exp_f32 v70, v70
  v_exp_f32 v71, v71
  v_pk_fma_f32 v[64:65], v[64:65], v[170:171], v[170:171] op_sel_hi:[1,0,0]
  v_pk_fma_f32 v[66:67], v[66:67], v[170:171], v[170:171] op_sel_hi:[1,0,0]
  v_pk_fma_f32 v[68:69], v[68:69], v[170:171], v[170:171] op_sel_hi:[1,0,0]
  v_pk_fma_f32 v[70:71], v[70:71], v[170:171], v[170:171] op_sel_hi:[1,0,0]
  v_rcp_f32 v64, v64
  v_rcp_f32 v65, v65
  v_rcp_f32 v66, v66
  v_rcp_f32 v67, v67
  v_rcp_f32 v68, v68
  v_rcp_f32 v69, v69
  v_rcp_f32 v70, v70
  v_rcp_f32 v71, v71
  v_pk_mul_f32 v[64:65], v[64:65], v[0:1]
  v_pk_mul_f32 v[66:67], v[66:67], v[2:3]
  v_pk_mul_f32 v[68:69], v[68:69], v[4:5]
  v_pk_mul_f32 v[70:71], v[70:71], v[6:7]
  v_cvt_pk_bf16_f32 v72, v64, v65
  v_cvt_pk_bf16_f32 v73, v66, v67
  v_cvt_pk_bf16_f32 v74, v68, v69
  v_cvt_pk_bf16_f32 v75, v70, v71
  v_xor_b32 v128, 0, v237
  ds_write_b128 v128, v[72:75]
  v_pk_fma_f32 v[8:9], v[180:181], v[168:169], v[8:9] op_sel_hi:[1,0,1]
  v_pk_fma_f32 v[10:11], v[182:183], v[168:169], v[10:11] op_sel_hi:[1,0,1]
  v_pk_fma_f32 v[12:13], v[184:185], v[168:169], v[12:13] op_sel_hi:[1,0,1]
  v_pk_fma_f32 v[14:15], v[186:187], v[168:169], v[14:15] op_sel_hi:[1,0,1]
  v_pk_mul_f32 v[80:81], v[8:9], v[8:9]
  v_pk_mul_f32 v[82:83], v[10:11], v[10:11]
  v_pk_mul_f32 v[84:85], v[12:13], v[12:13]
  v_pk_mul_f32 v[86:87], v[14:15], v[14:15]
  v_pk_fma_f32 v[80:81], v[80:81], v[166:167], v[166:167] op_sel:[0,1,0] op_sel_hi:[1,1,0]
  v_pk_fma_f32 v[82:83], v[82:83], v[166:167], v[166:167] op_sel:[0,1,0] op_sel_hi:[1,1,0]
  v_pk_fma_f32 v[84:85], v[84:85], v[166:167], v[166:167] op_sel:[0,1,0] op_sel_hi:[1,1,0]
  v_pk_fma_f32 v[86:87], v[86:87], v[166:167], v[166:167] op_sel:[0,1,0] op_sel_hi:[1,1,0]
  v_pk_mul_f32 v[80:81], v[80:81], v[8:9]
  v_pk_mul_f32 v[82:83], v[82:83], v[10:11]
  v_pk_mul_f32 v[84:85], v[84:85], v[12:13]
  v_pk_mul_f32 v[86:87], v[86:87], v[14:15]
  v_exp_f32 v80, v80
  v_exp_f32 v81, v81
  v_exp_f32 v82, v82
  v_exp_f32 v83, v83
  v_exp_f32 v84, v84
  v_exp_f32 v85, v85
  v_exp_f32 v86, v86
  v_exp_f32 v87, v87
  v_pk_fma_f32 v[80:81], v[80:81], v[170:171], v[170:171] op_sel_hi:[1,0,0]
  v_pk_fma_f32 v[82:83], v[82:83], v[170:171], v[170:171] op_sel_hi:[1,0,0]
  v_pk_fma_f32 v[84:85], v[84:85], v[170:171], v[170:171] op_sel_hi:[1,0,0]
  v_pk_fma_f32 v[86:87], v[86:87], v[170:171], v[170:171] op_sel_hi:[1,0,0]
  v_rcp_f32 v80, v80
  v_rcp_f32 v81, v81
  v_rcp_f32 v82, v82
  v_rcp_f32 v83, v83
  v_rcp_f32 v84, v84
  v_rcp_f32 v85, v85
  v_rcp_f32 v86, v86
  v_rcp_f32 v87, v87
  v_pk_mul_f32 v[80:81], v[80:81], v[8:9]
  v_pk_mul_f32 v[82:83], v[82:83], v[10:11]
  v_pk_mul_f32 v[84:85], v[84:85], v[12:13]
  v_pk_mul_f32 v[86:87], v[86:87], v[14:15]
  v_cvt_pk_bf16_f32 v88, v80, v81
  v_cvt_pk_bf16_f32 v89, v82, v83
  v_cvt_pk_bf16_f32 v90, v84, v85
  v_cvt_pk_bf16_f32 v91, v86, v87
  v_xor_b32 v129, 16, v237
  ds_write_b128 v129, v[88:91]
  s_cbranch_execz C_real
C_q2:
  v_pk_fma_f32 v[16:17], v[188:189], v[168:169], v[16:17] op_sel_hi:[1,0,1]
  v_pk_fma_f32 v[18:19], v[190:191], v[168:169], v[18:19] op_sel_hi:[1,0,1]
  v_pk_fma_f32 v[20:21], v[192:193], v[168:169], v[20:21] op_sel_hi:[1,0,1]
  v_pk_fma_f32 v[22:23], v[194:195], v[168:169], v[22:23] op_sel_hi:[1,0,1]
  v_pk_mul_f32 v[64:65], v[16:17], v[16:17]
  v_pk_mul_f32 v[66:67], v[18:19], v[18:19]
  v_pk_mul_f32 v[68:69], v[20:21], v[20:21]
  v_pk_mul_f32 v[70:71], v[22:23], v[22:23]
  v_pk_fma_f32 v[64:65], v[64:65], v[166:167], v[166:167] op_sel:[0,1,0] op_sel_hi:[1,1,0]
  v_pk_fma_f32 v[66:67], v[66:67], v[166:167], v[166:167] op_sel:[0,1,0] op_sel_hi:[1,1,0]
  v_pk_fma_f32 v[68:69], v[68:69], v[166:167], v[166:167] op_sel:[0,1,0] op_sel_hi:[1,1,0]
  v_pk_fma_f32 v[70:71], v[70:71], v[166:167], v[166:167] op_sel:[0,1,0] op_sel_hi:[1,1,0]
  v_pk_mul_f32 v[64:65], v[64:65], v[16:17]
  v_pk_mul_f32 v[66:67], v[66:67], v[18:19]
  v_pk_mul_f32 v[68:69], v[68:69], v[20:21]
  v_pk_mul_f32 v[70:71], v[70:71], v[22:23]
  v_exp_f32 v64, v64
  v_exp_f32 v65, v65
  v_exp_f32 v66, v66
  v_exp_f32 v67, v67
  v_exp_f32 v68, v68
  v_exp_f32 v69, v69
  v_exp_f32 v70, v70
  v_exp_f32 v71, v71
  v_pk_fma_f32 v[64:65], v[64:65], v[170:171], v[170:171] op_sel_hi:[1,0,0]
  v_pk_fma_f32 v[66:67], v[66:67], v[170:171], v[170:171] op_sel_hi:[1,0,0]
  v_pk_fma_f32 v[68:69], v[68:69], v[170:171], v[170:171] op_sel_hi:[1,0,0]
  v_pk_fma_f32 v[70:71], v[70:71], v[170:171], v[170:171] op_sel_hi:[1,0,0]
  v_rcp_f32 v64, v64
  v_rcp_f32 v65, v65
  v_rcp_f32 v66, v66
  v_rcp_f32 v67, v67
  v_rcp_f32 v68, v68
  v_rcp_f32 v69, v69
  v_rcp_f32 v70, v70
  v_rcp_f32 v71, v71
  v_pk_mul_f32 v[64:65], v[64:65], v[16:17]
  v_pk_mul_f32 v[66:67], v[66:67], v[18:19]
  v_pk_mul_f32 v[68:69], v[68:69], v[20:21]
  v_pk_mul_f32 v[70:71], v[70:71], v[22:23]
  v_cvt_pk_bf16_f32 v72, v64, v65
  v_cvt_pk_bf16_f32 v73, v66, v67
  v_cvt_pk_bf16_f32 v74, v68, v69
  v_cvt_pk_bf16_f32 v75, v70, v71
  v_xor_b32 v130, 32, v237
  ds_write_b128 v130, v[72:75]
  v_pk_fma_f32 v[24:25], v[196:197], v[168:169], v[24:25] op_sel_hi:[1,0,1]
  v_pk_fma_f32 v[26:27], v[198:199], v[168:169], v[26:27] op_sel_hi:[1,0,1]
  v_pk_fma_f32 v[28:29], v[200:201], v[168:169], v[28:29] op_sel_hi:[1,0,1]
  v_pk_fma_f32 v[30:31], v[202:203], v[168:169], v[30:31] op_sel_hi:[1,0,1]
  v_pk_mul_f32 v[80:81], v[24:25], v[24:25]
  v_pk_mul_f32 v[82:83], v[26:27], v[26:27]
  v_pk_mul_f32 v[84:85], v[28:29], v[28:29]
  v_pk_mul_f32 v[86:87], v[30:31], v[30:31]
  v_pk_fma_f32 v[80:81], v[80:81], v[166:167], v[166:167] op_sel:[0,1,0] op_sel_hi:[1,1,0]
  v_pk_fma_f32 v[82:83], v[82:83], v[166:167], v[166:167] op_sel:[0,1,0] op_sel_hi:[1,1,0]
  v_pk_fma_f32 v[84:85], v[84:85], v[166:167], v[166:167] op_sel:[0,1,0] op_sel_hi:[1,1,0]
  v_pk_fma_f32 v[86:87], v[86:87], v[166:167], v[166:167] op_sel:[0,1,0] op_sel_hi:[1,1,0]
  v_pk_mul_f32 v[80:81], v[80:81], v[24:25]
  v_pk_mul_f32 v[82:83], v[82:83], v[26:27]
  v_pk_mul_f32 v[84:85], v[84:85], v[28:29]
  v_pk_mul_f32 v[86:87], v[86:87], v[30:31]
  v_exp_f32 v80, v80
  v_exp_f32 v81, v81
  v_exp_f32 v82, v82
  v_exp_f32 v83, v83
  v_exp_f32 v84, v84
  v_exp_f32 v85, v85
  v_exp_f32 v86, v86
  v_exp_f32 v87, v87
  v_pk_fma_f32 v[80:81], v[80:81], v[170:171], v[170:171] op_sel_hi:[1,0,0]
  v_pk_fma_f32 v[82:83], v[82:83], v[170:171], v[170:171] op_sel_hi:[1,0,0]
  v_pk_fma_f32 v[84:85], v[84:85], v[170:171], v[170:171] op_sel_hi:[1,0,0]
  v_pk_fma_f32 v[86:87], v[86:87], v[170:171], v[170:171] op_sel_hi:[1,0,0]
  v_rcp_f32 v80, v80
  v_rcp_f32 v81, v81
  v_rcp_f32 v82, v82
  v_rcp_f32 v83, v83
  v_rcp_f32 v84, v84
  v_rcp_f32 v85, v85
  v_rcp_f32 v86, v86
  v_rcp_f32 v87, v87
  v_pk_mul_f32 v[80:81], v[80:81], v[24:25]
  v_pk_mul_f32 v[82:83], v[82:83], v[26:27]
  v_pk_mul_f32 v[84:85], v[84:85], v[28:29]
  v_pk_mul_f32 v[86:87], v[86:87], v[30:31]
  v_cvt_pk_bf16_f32 v88, v80, v81
  v_cvt_pk_bf16_f32 v89, v82, v83
  v_cvt_pk_bf16_f32 v90, v84, v85
  v_cvt_pk_bf16_f32 v91, v86, v87
  v_xor_b32 v131, 48, v237
  ds_write_b128 v131, v[88:91]
  ds_read_b128 v[0:3], v238 offset:0
  ds_read_b128 v[4:7], v238 offset:1024
  ds_read_b128 v[8:11], v238 offset:2048
  ds_read_b128 v[12:15], v238 offset:3072
  v_sub_f32 v168, 0, v141
  v_rcp_f32 v170, v145
  v_mul_f32 v166, 0xc0135761, v145
  v_mul_f32 v167, v145, v145
  v_mul_f32 v167, v167, v166
  v_mul_f32 v167, 0x3d372713, v167
  s_mov_b32 s56, 98304
  v_pk_fma_f32 v[32:33], v[172:173], v[168:169], v[32:33] op_sel_hi:[1,0,1]
  v_pk_fma_f32 v[34:35], v[174:175], v[168:169], v[34:35] op_sel_hi:[1,0,1]
  v_pk_fma_f32 v[36:37], v[176:177], v[168:169], v[36:37] op_sel_hi:[1,0,1]
  v_pk_fma_f32 v[38:39], v[178:179], v[168:169], v[38:39] op_sel_hi:[1,0,1]
  v_pk_mul_f32 v[64:65], v[32:33], v[32:33]
  v_pk_mul_f32 v[66:67], v[34:35], v[34:35]
  v_pk_mul_f32 v[68:69], v[36:37], v[36:37]
  v_pk_mul_f32 v[70:71], v[38:39], v[38:39]
  v_pk_fma_f32 v[64:65], v[64:65], v[166:167], v[166:167] op_sel:[0,1,0] op_sel_hi:[1,1,0]
  v_pk_fma_f32 v[66:67], v[66:67], v[166:167], v[166:167] op_sel:[0,1,0] op_sel_hi:[1,1,0]
  v_pk_fma_f32 v[68:69], v[68:69], v[166:167], v[166:167] op_sel:[0,1,0] op_sel_hi:[1,1,0]
  v_pk_fma_f32 v[70:71], v[70:71], v[166:167], v[166:167] op_sel:[0,1,0] op_sel_hi:[1,1,0]
  v_pk_mul_f32 v[64:65], v[64:65], v[32:33]
  v_pk_mul_f32 v[66:67], v[66:67], v[34:35]
  v_pk_mul_f32 v[68:69], v[68:69], v[36:37]
  v_pk_mul_f32 v[70:71], v[70:71], v[38:39]
  v_exp_f32 v64, v64
  v_exp_f32 v65, v65
  v_exp_f32 v66, v66
  v_exp_f32 v67, v67
  v_exp_f32 v68, v68
  v_exp_f32 v69, v69
  v_exp_f32 v70, v70
  v_exp_f32 v71, v71
  v_pk_fma_f32 v[64:65], v[64:65], v[170:171], v[170:171] op_sel_hi:[1,0,0]
  v_pk_fma_f32 v[66:67], v[66:67], v[170:171], v[170:171] op_sel_hi:[1,0,0]
  v_pk_fma_f32 v[68:69], v[68:69], v[170:171], v[170:171] op_sel_hi:[1,0,0]
  v_pk_fma_f32 v[70:71], v[70:71], v[170:171], v[170:171] op_sel_hi:[1,0,0]
  v_rcp_f32 v64, v64
  v_rcp_f32 v65, v65
  v_rcp_f32 v66, v66
  v_rcp_f32 v67, v67
  v_rcp_f32 v68, v68
  v_rcp_f32 v69, v69
  v_rcp_f32 v70, v70
  v_rcp_f32 v71, v71
  v_pk_mul_f32 v[64:65], v[64:65], v[32:33]
  v_pk_mul_f32 v[66:67], v[66:67], v[34:35]
  v_pk_mul_f32 v[68:69], v[68:69], v[36:37]
  v_pk_mul_f32 v[70:71], v[70:71], v[38:39]
  v_cvt_pk_bf16_f32 v72, v64, v65
  v_cvt_pk_bf16_f32 v73, v66, v67
  v_cvt_pk_bf16_f32 v74, v68, v69
  v_cvt_pk_bf16_f32 v75, v70, v71
  s_waitcnt lgkmcnt(0)
  s_cbranch_execz C_g3
  buffer_store_dwordx4 v[0:3], v236, s[16:19], s80 offen sc0 sc1
C_g3:
  s_cbranch_execz C_g4
  buffer_store_dwordx4 v[4:7], v236, s[16:19], s81 offen sc0 sc1
C_g4:
  s_cbranch_execz C_g5
  buffer_store_dwordx4 v[8:11], v236, s[16:19], s82 offen sc0 sc1
C_g5:
  s_cbranch_execz C_g6
  buffer_store_dwordx4 v[12:15], v236, s[16:19], s83 offen sc0 sc1
C_g6:
  ds_write_b128 v128, v[72:75]
  s_cbranch_execz C_real
C_q3:
  v_pk_fma_f32 v[40:41], v[180:181], v[168:169], v[40:41] op_sel_hi:[1,0,1]
  v_pk_fma_f32 v[42:43], v[182:183], v[168:169], v[42:43] op_sel_hi:[1,0,1]
  v_pk_fma_f32 v[44:45], v[184:185], v[168:169], v[44:45] op_sel_hi:[1,0,1]
  v_pk_fma_f32 v[46:47], v[186:187], v[168:169], v[46:47] op_sel_hi:[1,0,1]
  v_pk_mul_f32 v[80:81], v[40:41], v[40:41]
  v_pk_mul_f32 v[82:83], v[42:43], v[42:43]
  v_pk_mul_f32 v[84:85], v[44:45], v[44:45]
  v_pk_mul_f32 v[86:87], v[46:47], v[46:47]
  v_pk_fma_f32 v[80:81], v[80:81], v[166:167], v[166:167] op_sel:[0,1,0] op_sel_hi:[1,1,0]
  v_pk_fma_f32 v[82:83], v[82:83], v[166:167], v[166:167] op_sel:[0,1,0] op_sel_hi:[1,1,0]
  v_pk_fma_f32 v[84:85], v[84:85], v[166:167], v[166:167] op_sel:[0,1,0] op_sel_hi:[1,1,0]
  v_pk_fma_f32 v[86:87], v[86:87], v[166:167], v[166:167] op_sel:[0,1,0] op_sel_hi:[1,1,0]
  v_pk_mul_f32 v[80:81], v[80:81], v[40:41]
  v_pk_mul_f32 v[82:83], v[82:83], v[42:43]
  v_pk_mul_f32 v[84:85], v[84:85], v[44:45]
  v_pk_mul_f32 v[86:87], v[86:87], v[46:47]
  v_exp_f32 v80, v80
  v_exp_f32 v81, v81
  v_exp_f32 v82, v82
  v_exp_f32 v83, v83
  v_exp_f32 v84, v84
  v_exp_f32 v85, v85
  v_exp_f32 v86, v86
  v_exp_f32 v87, v87
  v_pk_fma_f32 v[80:81], v[80:81], v[170:171], v[170:171] op_sel_hi:[1,0,0]
  v_pk_fma_f32 v[82:83], v[82:83], v[170:171], v[170:171] op_sel_hi:[1,0,0]
  v_pk_fma_f32 v[84:85], v[84:85], v[170:171], v[170:171] op_sel_hi:[1,0,0]
  v_pk_fma_f32 v[86:87], v[86:87], v[170:171], v[170:171] op_sel_hi:[1,0,0]
  v_rcp_f32 v80, v80
  v_rcp_f32 v81, v81
  v_rcp_f32 v82, v82
  v_rcp_f32 v83, v83
  v_rcp_f32 v84, v84
  v_rcp_f32 v85, v85
  v_rcp_f32 v86, v86
  v_rcp_f32 v87, v87
  v_pk_mul_f32 v[80:81], v[80:81], v[40:41]
  v_pk_mul_f32 v[82:83], v[82:83], v[42:43]
  v_pk_mul_f32 v[84:85], v[84:85], v[44:45]
  v_pk_mul_f32 v[86:87], v[86:87], v[46:47]
  v_cvt_pk_bf16_f32 v88, v80, v81
  v_cvt_pk_bf16_f32 v89, v82, v83
  v_cvt_pk_bf16_f32 v90, v84, v85
  v_cvt_pk_bf16_f32 v91, v86, v87
  ds_write_b128 v129, v[88:91]
  v_pk_fma_f32 v[48:49], v[188:189], v[168:169], v[48:49] op_sel_hi:[1,0,1]
  v_pk_fma_f32 v[50:51], v[190:191], v[168:169], v[50:51] op_sel_hi:[1,0,1]
  v_pk_fma_f32 v[52:53], v[192:193], v[168:169], v[52:53] op_sel_hi:[1,0,1]
  v_pk_fma_f32 v[54:55], v[194:195], v[168:169], v[54:55] op_sel_hi:[1,0,1]
  v_pk_mul_f32 v[64:65], v[48:49], v[48:49]
  v_pk_mul_f32 v[66:67], v[50:51], v[50:51]
  v_pk_mul_f32 v[68:69], v[52:53], v[52:53]
  v_pk_mul_f32 v[70:71], v[54:55], v[54:55]
  v_pk_fma_f32 v[64:65], v[64:65], v[166:167], v[166:167] op_sel:[0,1,0] op_sel_hi:[1,1,0]
  v_pk_fma_f32 v[66:67], v[66:67], v[166:167], v[166:167] op_sel:[0,1,0] op_sel_hi:[1,1,0]
  v_pk_fma_f32 v[68:69], v[68:69], v[166:167], v[166:167] op_sel:[0,1,0] op_sel_hi:[1,1,0]
  v_pk_fma_f32 v[70:71], v[70:71], v[166:167], v[166:167] op_sel:[0,1,0] op_sel_hi:[1,1,0]
  v_pk_mul_f32 v[64:65], v[64:65], v[48:49]
  v_pk_mul_f32 v[66:67], v[66:67], v[50:51]
  v_pk_mul_f32 v[68:69], v[68:69], v[52:53]
  v_pk_mul_f32 v[70:71], v[70:71], v[54:55]
  v_exp_f32 v64, v64
  v_exp_f32 v65, v65
  v_exp_f32 v66, v66
  v_exp_f32 v67, v67
  v_exp_f32 v68, v68
  v_exp_f32 v69, v69
  v_exp_f32 v70, v70
  v_exp_f32 v71, v71
  v_pk_fma_f32 v[64:65], v[64:65], v[170:171], v[170:171] op_sel_hi:[1,0,0]
  v_pk_fma_f32 v[66:67], v[66:67], v[170:171], v[170:171] op_sel_hi:[1,0,0]
  v_pk_fma_f32 v[68:69], v[68:69], v[170:171], v[170:171] op_sel_hi:[1,0,0]
  v_pk_fma_f32 v[70:71], v[70:71], v[170:171], v[170:171] op_sel_hi:[1,0,0]
  v_rcp_f32 v64, v64
  v_rcp_f32 v65, v65
  v_rcp_f32 v66, v66
  v_rcp_f32 v67, v67
  v_rcp_f32 v68, v68
  v_rcp_f32 v69, v69
  v_rcp_f32 v70, v70
  v_rcp_f32 v71, v71
  v_pk_mul_f32 v[64:65], v[64:65], v[48:49]
  v_pk_mul_f32 v[66:67], v[66:67], v[50:51]
  v_pk_mul_f32 v[68:69], v[68:69], v[52:53]
  v_pk_mul_f32 v[70:71], v[70:71], v[54:55]
  v_cvt_pk_bf16_f32 v72, v64, v65
  v_cvt_pk_bf16_f32 v73, v66, v67
  v_cvt_pk_bf16_f32 v74, v68, v69
  v_cvt_pk_bf16_f32 v75, v70, v71
  ds_write_b128 v130, v[72:75]
  v_pk_fma_f32 v[56:57], v[196:197], v[168:169], v[56:57] op_sel_hi:[1,0,1]
  v_pk_fma_f32 v[58:59], v[198:199], v[168:169], v[58:59] op_sel_hi:[1,0,1]
  v_pk_fma_f32 v[60:61], v[200:201], v[168:169], v[60:61] op_sel_hi:[1,0,1]
  v_pk_fma_f32 v[62:63], v[202:203], v[168:169], v[62:63] op_sel_hi:[1,0,1]
  v_pk_mul_f32 v[80:81], v[56:57], v[56:57]
  v_pk_mul_f32 v[82:83], v[58:59], v[58:59]
  v_pk_mul_f32 v[84:85], v[60:61], v[60:61]
  v_pk_mul_f32 v[86:87], v[62:63], v[62:63]
  v_pk_fma_f32 v[80:81], v[80:81], v[166:167], v[166:167] op_sel:[0,1,0] op_sel_hi:[1,1,0]
  v_pk_fma_f32 v[82:83], v[82:83], v[166:167], v[166:167] op_sel:[0,1,0] op_sel_hi:[1,1,0]
  v_pk_fma_f32 v[84:85], v[84:85], v[166:167], v[166:167] op_sel:[0,1,0] op_sel_hi:[1,1,0]
  v_pk_fma_f32 v[86:87], v[86:87], v[166:167], v[166:167] op_sel:[0,1,0] op_sel_hi:[1,1,0]
  v_pk_mul_f32 v[80:81], v[80:81], v[56:57]
  v_pk_mul_f32 v[82:83], v[82:83], v[58:59]
  v_pk_mul_f32 v[84:85], v[84:85], v[60:61]
  v_pk_mul_f32 v[86:87], v[86:87], v[62:63]
  v_exp_f32 v80, v80
  v_exp_f32 v81, v81
  v_exp_f32 v82, v82
  v_exp_f32 v83, v83
  v_exp_f32 v84, v84
  v_exp_f32 v85, v85
  v_exp_f32 v86, v86
  v_exp_f32 v87, v87
  v_pk_fma_f32 v[80:81], v[80:81], v[170:171], v[170:171] op_sel_hi:[1,0,0]
  v_pk_fma_f32 v[82:83], v[82:83], v[170:171], v[170:171] op_sel_hi:[1,0,0]
  v_pk_fma_f32 v[84:85], v[84:85], v[170:171], v[170:171] op_sel_hi:[1,0,0]
  v_pk_fma_f32 v[86:87], v[86:87], v[170:171], v[170:171] op_sel_hi:[1,0,0]
  v_rcp_f32 v80, v80
  v_rcp_f32 v81, v81
  v_rcp_f32 v82, v82
  v_rcp_f32 v83, v83
  v_rcp_f32 v84, v84
  v_rcp_f32 v85, v85
  v_rcp_f32 v86, v86
  v_rcp_f32 v87, v87
  v_pk_mul_f32 v[80:81], v[80:81], v[56:57]
  v_pk_mul_f32 v[82:83], v[82:83], v[58:59]
  v_pk_mul_f32 v[84:85], v[84:85], v[60:61]
  v_pk_mul_f32 v[86:87], v[86:87], v[62:63]
  v_cvt_pk_bf16_f32 v88, v80, v81
  v_cvt_pk_bf16_f32 v89, v82, v83
  v_cvt_pk_bf16_f32 v90, v84, v85
  v_cvt_pk_bf16_f32 v91, v86, v87
  ds_write_b128 v131, v[88:91]
  ds_read_b128 v[32:35], v238 offset:0
  ds_read_b128 v[36:39], v238 offset:1024
  ds_read_b128 v[40:43], v238 offset:2048
  ds_read_b128 v[44:47], v238 offset:3072
  s_waitcnt lgkmcnt(3)
  s_cbranch_execz C_g7
  buffer_store_dwordx4 v[32:35], v236, s[16:19], s84 offen sc0 sc1
C_g7:
  s_waitcnt lgkmcnt(2)
  s_cbranch_execz C_g8
  buffer_store_dwordx4 v[36:39], v236, s[16:19], s85 offen sc0 sc1
C_g8:
  s_waitcnt lgkmcnt(1)
  s_cbranch_execz C_g9
  buffer_store_dwordx4 v[40:43], v236, s[16:19], s86 offen sc0 sc1
C_g9:
  s_waitcnt lgkmcnt(0)
  s_cbranch_execz C_g10
  buffer_store_dwordx4 v[44:47], v236, s[16:19], s87 offen sc0 sc1
C_g10:
  s_cbranch_execz C_real
  s_waitcnt vmcnt(0) lgkmcnt(0)
  s_endpgm
C_side:
  s_sub_u32 s2, s2, 192
  s_cmp_ge_u32 s2, 64
  s_cbranch_scc1 C_end
  s_load_dwordx2 s[4:5], s[0:1], 104
  s_load_dwordx2 s[6:7], s[0:1], 32
  s_load_dwordx2 s[32:33], s[0:1], 40
  v_mov_b32 v96, v0
  s_and_b32 s36, s60, 3
  s_lshl_b32 s37, s2, 2
  s_add_u32 s37, s37, 384
  s_add_u32 s37, s37, s36
  s_mul_i32 s38, s36, 40192
  s_add_u32 s38, s38, 1024
  v_and_b32 v100, 31, v96
  v_lshrrev_b32 v101, 5, v96
  s_lshl_b32 s39, s37, 12
  s_cmp_lt_u32 s60, 4
  s_cbranch_scc1 C_cc
  v_lshlrev_b32 v102, 7, v100
  v_lshl_add_u32 v102, v101, 6, v102
  v_lshlrev_b32 v103, 2, v96
  v_add_u32 v104, 2703360, v103
  s_mul_i32 s40, s37, 4224
  s_mov_b32 s50, 0
  s_waitcnt lgkmcnt(0)
  s_mov_b32 s8, s6
  s_mov_b32 s9, s7
  s_mov_b32 s10, 0x280000
  s_mov_b32 s11, 0x00020000
  s_add_u32 s12, s4, 0x2a0000
  s_addc_u32 s13, s5, 0
  s_mov_b32 s14, 0x528000
  s_mov_b32 s15, 0x00020000
  s_add_u32 m0, s38, 36096
  s_nop 0
  buffer_load_dwordx4 v102, s[8:11], s39 offen offset:0 lds
  s_add_u32 m0, s38, 37104
  s_nop 0
  buffer_load_dwordx4 v102, s[8:11], s39 offen offset:16 lds
  s_add_u32 m0, s38, 38112
  s_nop 0
  buffer_load_dwordx4 v102, s[8:11], s39 offen offset:32 lds
  s_add_u32 m0, s38, 39120
  s_nop 0
  buffer_load_dwordx4 v102, s[8:11], s39 offen offset:48 lds
  s_add_u32 s38, s38, 8192
  s_add_u32 s40, s40, 2048
C_cll:
  s_add_u32 m0, s38, 8192
  s_add_u32 s42, s40, 2048
  buffer_load_dwordx4 v103, s[12:15], s42 offen lds
  s_add_u32 m0, s38, 25728
  s_add_u32 s50, s50, 1
  buffer_load_dwordx4 v104, s[12:15], s42 offen lds
C_cl1:
  s_mov_b32 m0, s38
  s_nop 0
  buffer_load_dwordx4 v103, s[12:15], s40 offen lds
  s_add_u32 m0, s38, 17536
  s_sub_u32 s38, s38, 1024
  buffer_load_dwordx4 v104, s[12:15], s40 offen lds
  s_sub_u32 s40, s40, 256
  s_cmp_eq_u32 s50, 9
  s_cbranch_scc1 C_cl2
  s_cmp_lg_u32 s50, 5
  s_cbranch_scc1 C_cl3
  s_waitcnt vmcnt(12)
  s_barrier
C_cl3:
  s_cmp_lg_u32 s50, 7
  s_cbranch_scc1 C_cl4
  s_waitcnt vmcnt(12)
  s_barrier
C_cl4:
  s_cmp_lt_u32 s50, 8
  s_cbranch_scc1 C_cll
  s_mov_b32 s50, 9
  s_branch C_cl1
C_cl2:
  s_waitcnt vmcnt(0)
  s_barrier
  s_load_dwordx2 s[6:7], s[0:1], 80
  s_lshr_b32 s63, s2, 3
  s_lshl_b32 s63, s63, 2
  s_add_u32 s63, s63, s36
  v_lshlrev_b32 v1, 7, v0
  s_waitcnt lgkmcnt(0)
  s_lshl_b32 s63, s63, 13
  s_mov_b32 s12, s6
  s_mov_b32 s13, s7
  s_mov_b32 s14, 0x1e0000
  s_mov_b32 s15, 0x00020000
  s_mov_b32 s62, 8
C_wpf:
  s_min_u32 s63, s63, 1957888
  s_sub_u32 s62, s62, 1
  buffer_load_dword v2, v1, s[12:15], s63 offen sc1
  s_add_u32 s63, s63, 262144
  s_cmp_lg_u32 s62, 0
  s_cbranch_scc1 C_wpf
  s_waitcnt vmcnt(0) lgkmcnt(0)
  s_endpgm
C_cc:
  v_bfe_u32 v102, v96, 2, 1
  v_lshlrev_b32 v102, 4, v102
  v_bfe_u32 v103, v96, 3, 2
  v_lshl_add_u32 v102, v103, 2, v102
  v_and_b32 v103, 3, v96
  v_add_u32 v102, v102, v103
  v_lshl_add_u32 v102, v101, 5, v102
  v_and_b32 v103, 1, v102
  v_xor_b32 v103, 1, v103
  v_mul_u32_u24 v103, 17536, v103
  v_lshrrev_b32 v102, 1, v102
  v_sub_u32 v102, 511, v102
  v_lshl_add_u32 v102, v102, 4, v103
  v_add_u32 v97, s38, v102
  v_bfe_u32 v102, v96, 4, 1
  v_and_b32 v103, 15, v96
  v_lshl_add_u32 v103, v103, 1, v102
  v_sub_u32 v104, v103, v101
  v_and_b32 v105, 1, v104
  v_ashrrev_i32 v106, 1, v104
  v_lshl_add_u32 v106, v105, 5, v106
  s_add_u32 s42, s38, 36096
  v_lshl_add_u32 v98, v106, 4, s42
  v_cmp_gt_i32 vcc, 0, v104
  v_lshlrev_b32 v117, 6, v103
  v_lshl_add_u32 v117, v101, 5, v117
  v_lshlrev_b32 v118, 2, v117
  s_add_u32 s42, s38, 8064
  v_sub_u32 v118, s42, v118
  v_bfe_u32 v105, v117, 4, 3
  v_and_b32 v106, 7, v96
  v_xor_b32 v105, v105, v106
  v_and_b32 v117, 0x780, v117
  v_lshl_add_u32 v117, v105, 4, v117
  v_add_u32 v119, s38, v117
  v_xor_b32 v120, 16, v119
  v_lshl_add_u32 v121, v96, 4, s38
  v_lshrrev_b32 v105, 3, v96
  v_xor_b32 v106, v106, v105
  v_lshlrev_b32 v105, 7, v105
  v_lshl_add_u32 v117, v106, 4, v105
  s_lshl_b32 s41, s37, 1
  v_mov_b32 v105, s41
  s_waitcnt lgkmcnt(0)
  s_add_u32 s16, s4, 0x1200000
  s_addc_u32 s17, s5, 0
  s_mov_b32 s18, 0x280000
  s_mov_b32 s19, 0x00020000
  s_mov_b32 s20, s32
  s_mov_b32 s21, s33
  s_mov_b32 s22, 0x500
  s_mov_b32 s23, 0x00020000
  buffer_load_ushort v116, v105, s[20:23], 0 offen
  s_mov_b64 exec, 0
  s_mov_b32 s50, 16
  s_branch C_cl
C_creal:
  s_mov_b64 exec, -1
  v_mov_b32 v0, 0
  v_mov_b32 v1, 0
  v_mov_b32 v2, 0
  v_mov_b32 v3, 0
  v_mov_b32 v4, 0
  v_mov_b32 v5, 0
  v_mov_b32 v6, 0
  v_mov_b32 v7, 0
  v_mov_b32 v8, 0
  v_mov_b32 v9, 0
  v_mov_b32 v10, 0
  v_mov_b32 v11, 0
  v_mov_b32 v12, 0
  v_mov_b32 v13, 0
  v_mov_b32 v14, 0
  v_mov_b32 v15, 0
  v_mov_b32 v16, 0
  v_mov_b32 v17, 0
  v_mov_b32 v18, 0
  v_mov_b32 v19, 0
  v_mov_b32 v20, 0
  v_mov_b32 v21, 0
  v_mov_b32 v22, 0
  v_mov_b32 v23, 0
  v_mov_b32 v24, 0
  v_mov_b32 v25, 0
  v_mov_b32 v26, 0
  v_mov_b32 v27, 0
  v_mov_b32 v28, 0
  v_mov_b32 v29, 0
  v_mov_b32 v30, 0
  v_mov_b32 v31, 0
  s_barrier
  ds_read_b128 v[32:35], v98 offset:0
  ds_read_b128 v[36:39], v98 offset:1024
  ds_read_b128 v[40:43], v98 offset:2048
  ds_read_b128 v[44:47], v98 offset:3072
  ds_read_b128 v[48:51], v97 offset:8192
  ds_read_b128 v[56:59], v98 offset:256
  ds_read_b128 v[52:55], v97 offset:0
  ds_read_b128 v[60:63], v97 offset:8256
  ds_read_b128 v[68:71], v98 offset:1280
  ds_read_b128 v[64:67], v97 offset:64
  ds_read_b128 v[72:75], v97 offset:8320
  ds_read_b128 v[80:83], v98 offset:2304
  ds_read_b128 v[76:79], v97 offset:128
  s_waitcnt lgkmcnt(9)
  v_cndmask_b32 v32, v32, v0, vcc
  v_cndmask_b32 v33, v33, v0, vcc
  v_cndmask_b32 v34, v34, v0, vcc
  v_cndmask_b32 v35, v35, v0, vcc
  v_cndmask_b32 v36, v36, v0, vcc
  v_cndmask_b32 v37, v37, v0, vcc
  v_cndmask_b32 v38, v38, v0, vcc
  v_cndmask_b32 v39, v39, v0, vcc
  v_cndmask_b32 v40, v40, v0, vcc
  v_cndmask_b32 v41, v41, v0, vcc
  v_cndmask_b32 v42, v42, v0, vcc
  v_cndmask_b32 v43, v43, v0, vcc
  v_cndmask_b32 v44, v44, v0, vcc
  v_cndmask_b32 v45, v45, v0, vcc
  v_cndmask_b32 v46, v46, v0, vcc
  v_cndmask_b32 v47, v47, v0, vcc
  s_mov_b32 s50, 0
  s_nop 0
C_cl:
  s_waitcnt lgkmcnt(6)
  v_mfma_f32_32x32x16_bf16 v[0:15], v[48:51], v[32:35], v[0:15]
  ds_read_b128 v[84:87], v97 offset:8384
  v_mfma_f32_32x32x16_bf16 v[16:31], v[52:55], v[32:35], v[16:31]
  ds_read_b128 v[92:95], v98 offset:3328
  s_lshr_b32 s51, 0x22, s50
  s_add_u32 s50, s50, 1
  v_mfma_f32_32x32x16_bf16 v[16:31], v[48:51], v[56:59], v[16:31]
  ds_read_b128 v[88:91], v97 offset:192
  v_add_u32 v97, -512, v97
  v_add_u32 v98, -16, v98
  s_bitcmp0_b32 s51, 0
  s_waitcnt lgkmcnt(6)
  v_mfma_f32_32x32x16_bf16 v[0:15], v[60:63], v[36:39], v[0:15]
  s_cbranch_scc1 C_nb
  s_barrier
C_nb:
  ds_read_b128 v[48:51], v97 offset:8192
  v_mfma_f32_32x32x16_bf16 v[16:31], v[64:67], v[36:39], v[16:31]
  ds_read_b128 v[56:59], v98 offset:256
  v_mov_b32_dpp v32, v32 row_shr:1 row_mask:0xf bank_mask:0xf bound_ctrl:0
  v_mov_b32_dpp v33, v33 row_shr:1 row_mask:0xf bank_mask:0xf bound_ctrl:0
  v_mfma_f32_32x32x16_bf16 v[16:31], v[60:63], v[68:71], v[16:31]
  ds_read_b128 v[52:55], v97 offset:0
  v_mov_b32_dpp v34, v34 row_shr:1 row_mask:0xf bank_mask:0xf bound_ctrl:0
  v_mov_b32_dpp v35, v35 row_shr:1 row_mask:0xf bank_mask:0xf bound_ctrl:0
  s_waitcnt lgkmcnt(6)
  v_mfma_f32_32x32x16_bf16 v[0:15], v[72:75], v[40:43], v[0:15]
  ds_read_b128 v[60:63], v97 offset:8256
  v_mov_b32_dpp v36, v36 row_shr:1 row_mask:0xf bank_mask:0xf bound_ctrl:0
  v_mov_b32_dpp v37, v37 row_shr:1 row_mask:0xf bank_mask:0xf bound_ctrl:0
  v_mfma_f32_32x32x16_bf16 v[16:31], v[76:79], v[40:43], v[16:31]
  ds_read_b128 v[68:71], v98 offset:1280
  v_mov_b32_dpp v38, v38 row_shr:1 row_mask:0xf bank_mask:0xf bound_ctrl:0
  v_mov_b32_dpp v39, v39 row_shr:1 row_mask:0xf bank_mask:0xf bound_ctrl:0
  v_mfma_f32_32x32x16_bf16 v[16:31], v[72:75], v[80:83], v[16:31]
  ds_read_b128 v[64:67], v97 offset:64
  s_cmp_lt_u32 s50, 16
  s_waitcnt lgkmcnt(6)
  v_mfma_f32_32x32x16_bf16 v[0:15], v[84:87], v[44:47], v[0:15]
  ds_read_b128 v[72:75], v97 offset:8320
  v_mov_b32_dpp v40, v40 row_shr:1 row_mask:0xf bank_mask:0xf bound_ctrl:0
  v_mov_b32_dpp v41, v41 row_shr:1 row_mask:0xf bank_mask:0xf bound_ctrl:0
  v_mfma_f32_32x32x16_bf16 v[16:31], v[88:91], v[44:47], v[16:31]
  ds_read_b128 v[80:83], v98 offset:2304
  v_mov_b32_dpp v42, v42 row_shr:1 row_mask:0xf bank_mask:0xf bound_ctrl:0
  v_mov_b32_dpp v43, v43 row_shr:1 row_mask:0xf bank_mask:0xf bound_ctrl:0
  v_mov_b32_dpp v44, v44 row_shr:1 row_mask:0xf bank_mask:0xf bound_ctrl:0
  v_mfma_f32_32x32x16_bf16 v[16:31], v[84:87], v[92:95], v[16:31]
  ds_read_b128 v[76:79], v97 offset:128
  v_mov_b32_dpp v45, v45 row_shr:1 row_mask:0xf bank_mask:0xf bound_ctrl:0
  v_mov_b32_dpp v46, v46 row_shr:1 row_mask:0xf bank_mask:0xf bound_ctrl:0
  v_mov_b32_dpp v47, v47 row_shr:1 row_mask:0xf bank_mask:0xf bound_ctrl:0
  s_cbranch_scc1 C_cl
  s_waitcnt lgkmcnt(0)
  ds_read_b128 v[48:51], v118 offset:8256
  ds_read_b128 v[52:55], v118 offset:8192
  ds_read_b128 v[56:59], v118 offset:64
  ds_read_b128 v[60:63], v118 offset:0
  s_cbranch_execz C_cg
  s_waitcnt vmcnt(0)
C_cg:
  v_lshlrev_b32 v116, 16, v116
  s_mov_b32 s54, 0xffff0000
  s_nop 3
  s_waitcnt lgkmcnt(0)
  v_lshlrev_b32 v100, 16, v48
  v_and_b32 v101, s54, v48
  v_fmac_f32 v7, v100, v116
  v_fmac_f32 v6, v101, v116
  v_lshlrev_b32 v100, 16, v49
  v_and_b32 v101, s54, v49
  v_fmac_f32 v5, v100, v116
  v_fmac_f32 v4, v101, v116
  v_lshlrev_b32 v100, 16, v50
  v_and_b32 v101, s54, v50
  v_fmac_f32 v3, v100, v116
  v_fmac_f32 v2, v101, v116
  v_lshlrev_b32 v100, 16, v51
  v_and_b32 v101, s54, v51
  v_fmac_f32 v1, v100, v116
  v_fmac_f32 v0, v101, v116
  v_cvt_pk_bf16_f32 v32, v0, v1
  v_cvt_pk_bf16_f32 v33, v2, v3
  v_cvt_pk_bf16_f32 v34, v4, v5
  v_cvt_pk_bf16_f32 v35, v6, v7
  ds_write_b128 v119, v[32:35] offset:0
  v_lshlrev_b32 v100, 16, v52
  v_and_b32 v101, s54, v52
  v_fmac_f32 v15, v100, v116
  v_fmac_f32 v14, v101, v116
  v_lshlrev_b32 v100, 16, v53
  v_and_b32 v101, s54, v53
  v_fmac_f32 v13, v100, v116
  v_fmac_f32 v12, v101, v116
  v_lshlrev_b32 v100, 16, v54
  v_and_b32 v101, s54, v54
  v_fmac_f32 v11, v100, v116
  v_fmac_f32 v10, v101, v116
  v_lshlrev_b32 v100, 16, v55
  v_and_b32 v101, s54, v55
  v_fmac_f32 v9, v100, v116
  v_fmac_f32 v8, v101, v116
  v_cvt_pk_bf16_f32 v36, v8, v9
  v_cvt_pk_bf16_f32 v37, v10, v11
  v_cvt_pk_bf16_f32 v38, v12, v13
  v_cvt_pk_bf16_f32 v39, v14, v15
  ds_write_b128 v120, v[36:39] offset:0
  v_lshlrev_b32 v100, 16, v56
  v_and_b32 v101, s54, v56
  v_fmac_f32 v23, v100, v116
  v_fmac_f32 v22, v101, v116
  v_lshlrev_b32 v100, 16, v57
  v_and_b32 v101, s54, v57
  v_fmac_f32 v21, v100, v116
  v_fmac_f32 v20, v101, v116
  v_lshlrev_b32 v100, 16, v58
  v_and_b32 v101, s54, v58
  v_fmac_f32 v19, v100, v116
  v_fmac_f32 v18, v101, v116
  v_lshlrev_b32 v100, 16, v59
  v_and_b32 v101, s54, v59
  v_fmac_f32 v17, v100, v116
  v_fmac_f32 v16, v101, v116
  v_cvt_pk_bf16_f32 v40, v16, v17
  v_cvt_pk_bf16_f32 v41, v18, v19
  v_cvt_pk_bf16_f32 v42, v20, v21
  v_cvt_pk_bf16_f32 v43, v22, v23
  ds_write_b128 v119, v[40:43] offset:2048
  v_lshlrev_b32 v100, 16, v60
  v_and_b32 v101, s54, v60
  v_fmac_f32 v31, v100, v116
  v_fmac_f32 v30, v101, v116
  v_lshlrev_b32 v100, 16, v61
  v_and_b32 v101, s54, v61
  v_fmac_f32 v29, v100, v116
  v_fmac_f32 v28, v101, v116
  v_lshlrev_b32 v100, 16, v62
  v_and_b32 v101, s54, v62
  v_fmac_f32 v27, v100, v116
  v_fmac_f32 v26, v101, v116
  v_lshlrev_b32 v100, 16, v63
  v_and_b32 v101, s54, v63
  v_fmac_f32 v25, v100, v116
  v_fmac_f32 v24, v101, v116
  v_cvt_pk_bf16_f32 v44, v24, v25
  v_cvt_pk_bf16_f32 v45, v26, v27
  v_cvt_pk_bf16_f32 v46, v28, v29
  v_cvt_pk_bf16_f32 v47, v30, v31
  ds_write_b128 v120, v[44:47] offset:2048
  ds_read_b128 v[0:3], v121 offset:0
  ds_read_b128 v[4:7], v121 offset:1024
  ds_read_b128 v[8:11], v121 offset:2048
  ds_read_b128 v[12:15], v121 offset:3072
  s_cbranch_execz C_creal
  s_waitcnt lgkmcnt(3)
  buffer_store_dwordx4 v[0:3], v117, s[16:19], s39 offen offset:0 sc0 sc1
  s_waitcnt lgkmcnt(2)
  buffer_store_dwordx4 v[4:7], v117, s[16:19], s39 offen offset:1024 sc0 sc1
  s_waitcnt lgkmcnt(1)
  buffer_store_dwordx4 v[8:11], v117, s[16:19], s39 offen offset:2048 sc0 sc1
  s_waitcnt lgkmcnt(0)
  buffer_store_dwordx4 v[12:15], v117, s[16:19], s39 offen offset:3072 sc0 sc1
  s_waitcnt vmcnt(0) lgkmcnt(0)
  s_endpgm
C_end:
  s_waitcnt lgkmcnt(0)
  s_endpgm
.globl kD_kernel
.p2align 8
.type kD_kernel,@function
kD_kernel:
  v_lshrrev_b32 v1, 6, v0
  v_and_b32 v0, 63, v0
  v_readfirstlane_b32 s60, v1
  s_cmp_ge_u32 s2, 224
  s_cbranch_scc1 D_side
  s_load_dwordx2 s[4:5], s[0:1], 104
  s_load_dwordx2 s[6:7], s[0:1], 80
  s_load_dwordx2 s[32:33], s[0:1], 0
  s_load_dwordx2 s[34:35], s[0:1], 88
  s_and_b32 s36, s60, 3
  s_and_b32 s37, s2, 7
  s_lshr_b32 s38, s2, 3
  s_mul_i32 s37, s37, 28
  s_add_u32 s38, s38, s37
  s_cmp_ge_u32 s38, 220
  s_cbranch_scc1 D_end
  s_cmp_eq_u32 s60, 3
  s_cbranch_scc1 D_end
  s_mul_i32 s37, s38, 6554
  s_lshr_b32 s37, s37, 16
  s_mul_i32 s39, s37, 10
  s_sub_u32 s38, s38, s39
  s_mul_i32 s40, s37, 96
  s_mul_i32 s41, s38, 64
  s_cmp_lt_u32 s60, 4
  s_cbranch_scc1 D_comp
  v_lshrrev_b32 v1, 3, v0
  s_mul_i32 s44, s36, 24
  s_add_u32 s44, s44, s40
  v_add_u32 v1, s44, v1
  v_mul_u32_u24 v1, 3072, v1
  v_lshrrev_b32 v2, 4, v0
  v_and_b32 v3, 7, v0
  v_xor_b32 v2, v2, v3
  v_lshlrev_b32 v2, 4, v2
  s_and_b32 s44, s36, 1
  s_lshl_b32 s44, s44, 6
  v_xor_b32 v2, s44, v2
  v_xor_b32 v3, 64, v2
  v_add_u32 v8, v1, v2
  v_add_u32 v9, v1, v3
  v_add_u32 v9, 24576, v9
  v_add_u32 v10, 49152, v8
  v_add_u32 v11, 49152, v9
  v_lshrrev_b32 v1, 3, v0
  v_and_b32 v2, 7, v0
  v_and_b32 v3, 2, v1
  v_xor_b32 v2, v2, v3
  s_lshl_b32 s44, s36, 4
  v_add_u32 v1, s44, v1
  v_mul_u32_u24 v1, 1280, v1
  v_lshl_add_u32 v1, v2, 4, v1
  s_lshl_b32 s44, s41, 1
  v_add_u32 v12, s44, v1
  v_add_u32 v13, 10240, v12
  s_mul_i32 s46, s36, 3072
  s_mul_i32 s47, s36, 2048
  s_add_u32 s47, s47, 12288
  s_mov_b32 s48, 0
  s_mov_b32 s49, 0
  s_mov_b32 s50, 0
  s_mov_b32 s52, 0
  s_waitcnt lgkmcnt(0)
  s_add_u32 s8, s4, 0xb00000
  s_addc_u32 s9, s5, 0
  s_mov_b32 s10, 0x600000
  s_mov_b32 s11, 0x00020000
  s_mov_b32 s12, s6
  s_mov_b32 s13, s7
  s_mov_b32 s14, 0x1e0000
  s_mov_b32 s15, 0x00020000
D_ll:
  s_add_u32 m0, s46, 0
  s_nop 0
  buffer_load_dwordx4 v8, s[8:11], s48 offen lds
  s_add_u32 m0, s46, 1024
  s_nop 0
  buffer_load_dwordx4 v9, s[8:11], s48 offen lds
  s_add_u32 m0, s46, 2048
  s_nop 0
  buffer_load_dwordx4 v10, s[8:11], s48 offen lds
  s_add_u32 m0, s47, 0
  s_nop 0
  buffer_load_dwordx4 v12, s[12:15], s49 offen lds
  s_add_u32 m0, s47, 1024
  s_nop 0
  buffer_load_dwordx4 v13, s[12:15], s49 offen lds
  s_add_u32 s52, s52, 1
  s_cmp_eq_u32 s52, 6
  s_cselect_b32 s52, 0, s52
  s_mov_b32 s53, 20480
  s_cselect_b32 s53, -102400, s53
  s_add_u32 s46, s46, s53
  s_add_u32 s47, s47, s53
  s_add_u32 s48, s48, 128
  s_add_u32 s49, s49, 81920
  s_add_u32 s50, s50, 1
  s_cmp_lt_u32 s50, 4
  s_cbranch_scc1 D_ll
  s_waitcnt vmcnt(15)
  s_barrier
  s_cmp_lt_u32 s50, 24
  s_cbranch_scc1 D_ll
  s_add_u32 s24, s4, 0x1200000
  s_addc_u32 s25, s5, 0
  s_mov_b32 s26, 0x280000
  s_mov_b32 s27, 0x00020000
  v_lshrrev_b32 v1, 4, v0
  v_and_b32 v2, 15, v0
  v_lshlrev_b32 v3, 2, v1
  v_xor_b32 v2, v2, v3
  s_lshl_b32 s44, s36, 4
  s_add_u32 s44, s44, s41
  v_add_u32 v1, s44, v1
  v_lshlrev_b32 v1, 12, v1
  v_lshl_add_u32 v1, v2, 4, v1
  s_lshl_b32 s44, s40, 1
  s_lshl_b32 s45, s36, 12
  s_add_u32 m0, s45, 122880
  s_nop 0
  buffer_load_dwordx4 v1, s[24:27], s44 offen lds
  s_add_u32 s44, s44, 16384
  s_add_u32 m0, s45, 123904
  s_nop 0
  buffer_load_dwordx4 v1, s[24:27], s44 offen lds
  s_add_u32 s44, s44, 16384
  s_add_u32 m0, s45, 124928
  s_nop 0
  buffer_load_dwordx4 v1, s[24:27], s44 offen lds
  s_add_u32 s44, s44, 16384
  s_add_u32 m0, s45, 125952
  s_nop 0
  buffer_load_dwordx4 v1, s[24:27], s44 offen lds
  s_add_u32 s44, s44, 16384
  s_waitcnt vmcnt(14)
  s_barrier
  s_waitcnt vmcnt(9)
  s_barrier
  s_waitcnt vmcnt(4)
  s_barrier
  s_waitcnt vmcnt(0)
  s_barrier
  s_waitcnt vmcnt(0) lgkmcnt(0)
  s_endpgm
D_comp:
  v_mov_b32 v194, v0
  s_mov_b32 s42, s36
  s_mov_b32 s43, 0
  v_and_b32 v144, 31, v194
  v_lshrrev_b32 v145, 5, v194
  s_mul_i32 s44, s42, 32
  s_add_u32 s44, s44, s40
  v_add_u32 v146, s44, v144
  s_lshl_b32 s45, s43, 6
  s_add_u32 s45, s45, s41
  v_lshl_add_u32 v147, v145, 5, s45
  v_mul_u32_u24 v190, 1280, v146
  v_lshl_add_u32 v190, v147, 1, v190
  v_lshlrev_b32 v191, 3, v146
  v_mul_u32_u24 v192, 80, v146
  s_waitcnt lgkmcnt(0)
  s_mov_b32 s16, s34
  s_mov_b32 s17, s35
  s_mov_b32 s18, 0x280000
  s_mov_b32 s19, 0x00020000
  v_lshrrev_b32 v140, 3, v194
  v_and_b32 v141, 7, v194
  v_xor_b32 v142, v140, v141
  s_mul_i32 s44, s42, 32
  s_add_u32 s44, s44, s40
  v_add_u32 v140, s44, v140
  v_mul_u32_u24 v140, 1280, v140
  s_lshl_b32 s44, s43, 6
  s_add_u32 s44, s44, s41
  v_lshl_add_u32 v199, v142, 3, s44
  v_lshl_add_u32 v196, v199, 1, v140
  s_mul_i32 s45, s36, 8192
  s_add_u32 s45, s45, 139264
  v_lshl_add_u32 v198, v194, 4, s45
  v_lshlrev_b32 v140, 2, v145
  v_xor_b32 v140, v140, v141
  v_lshlrev_b32 v140, 4, v140
  v_lshl_add_u32 v140, v144, 7, v140
  v_add_u32 v197, s45, v140
  s_mov_b32 s80, 0
  s_mov_b32 s81, 10240
  s_mov_b32 s82, 20480
  s_mov_b32 s83, 30720
  s_mov_b32 s20, s32
  s_mov_b32 s21, s33
  s_mov_b32 s22, 0x280000
  s_mov_b32 s23, 0x00020000
  s_add_u32 s28, s4, 0x290000
  s_addc_u32 s29, s5, 0
  s_mov_b32 s30, 0x4000
  s_mov_b32 s31, 0x00020000
  s_add_u32 m0, s45, 0
  s_nop 0
  buffer_load_dwordx4 v196, s[20:23], s80 offen lds
  s_add_u32 m0, s45, 1024
  s_nop 0
  buffer_load_dwordx4 v196, s[20:23], s81 offen lds
  s_add_u32 m0, s45, 2048
  s_nop 0
  buffer_load_dwordx4 v196, s[20:23], s82 offen lds
  s_add_u32 m0, s45, 3072
  s_nop 0
  buffer_load_dwordx4 v196, s[20:23], s83 offen lds
  buffer_load_dwordx2 v[188:189], v191, s[28:31], 0 offen
  s_add_u32 s24, s4, 0x800000
  s_addc_u32 s25, s5, 0
  s_mov_b32 s26, 0x280000
  s_mov_b32 s27, 0x00020000
  s_add_u32 m0, s45, 4096
  s_nop 0
  buffer_load_dwordx4 v196, s[24:27], s80 offen lds
  s_add_u32 m0, s45, 5120
  s_nop 0
  buffer_load_dwordx4 v196, s[24:27], s81 offen lds
  s_add_u32 m0, s45, 6144
  s_nop 0
  buffer_load_dwordx4 v196, s[24:27], s82 offen lds
  s_add_u32 m0, s45, 7168
  s_nop 0
  buffer_load_dwordx4 v196, s[24:27], s83 offen lds
  v_lshrrev_b32 v140, 1, v144
  v_and_b32 v140, 7, v140
  v_xor_b32 v140, v140, v145
  v_lshlrev_b32 v140, 4, v140
  v_lshl_add_u32 v140, v144, 7, v140
  s_mul_i32 s44, s42, 4096
  v_add_u32 v140, s44, v140
  v_xor_b32 v112, 0, v140
  v_xor_b32 v113, 32, v140
  v_xor_b32 v114, 64, v140
  v_xor_b32 v115, 96, v140
  v_bfe_u32 v140, v194, 2, 2
  v_lshl_add_u32 v141, v145, 3, v140
  v_mul_u32_u24 v141, 128, v141
  v_and_b32 v142, 1, v194
  v_lshlrev_b32 v142, 6, v142
  v_bfe_u32 v143, v194, 1, 1
  v_lshl_or_b32 v142, v143, 3, v142
  v_bfe_u32 v143, v194, 4, 1
  v_lshl_or_b32 v142, v143, 4, v142
  v_and_b32 v143, 2, v140
  v_lshlrev_b32 v143, 4, v143
  v_xor_b32 v142, v142, v143
  v_add_u32 v141, v141, v142
  v_add_u32 v141, 12288, v141
  v_mov_b32 v116, v141
  v_xor_b32 v117, 32, v141
  v_bfe_u32 v140, v194, 2, 2
  v_lshl_add_u32 v193, v145, 5, v140
  v_lshlrev_b32 v193, 8, v193
  v_xor_b32 v140, s36, v140
  v_lshl_add_u32 v193, v140, 6, v193
  v_bfe_u32 v140, v194, 4, 1
  v_lshl_add_u32 v193, v140, 5, v193
  v_and_b32 v140, 3, v194
  v_lshl_add_u32 v193, v140, 3, v193
  v_add_u32 v193, 122880, v193
  s_mov_b64 exec, 0
  s_mov_b32 s50, 24
  s_cmp_eq_u32 s36, 1
  s_cbranch_scc1 D_q1
  s_cmp_eq_u32 s36, 2
  s_cbranch_scc1 D_q2
  s_cmp_eq_u32 s36, 3
  s_cbranch_scc1 D_q3
  s_branch D_loop
D_real:
  s_mov_b64 exec, -1
  s_mov_b32 s61, -81920
  s_mov_b32 s62, 40960
  s_nop 7
  s_nop 7
  v_mov_b32 v0, 0
  v_mov_b32 v1, 0
  v_mov_b32 v2, 0
  v_mov_b32 v3, 0
  v_mov_b32 v4, 0
  v_mov_b32 v5, 0
  v_mov_b32 v6, 0
  v_mov_b32 v7, 0
  v_mov_b32 v8, 0
  v_mov_b32 v9, 0
  v_mov_b32 v10, 0
  v_mov_b32 v11, 0
  v_mov_b32 v12, 0
  v_mov_b32 v13, 0
  v_mov_b32 v14, 0
  v_mov_b32 v15, 0
  v_mov_b32 v16, 0
  v_mov_b32 v17, 0
  v_mov_b32 v18, 0
  v_mov_b32 v19, 0
  v_mov_b32 v20, 0
  v_mov_b32 v21, 0
  v_mov_b32 v22, 0
  v_mov_b32 v23, 0
  v_mov_b32 v24, 0
  v_mov_b32 v25, 0
  v_mov_b32 v26, 0
  v_mov_b32 v27, 0
  v_mov_b32 v28, 0
  v_mov_b32 v29, 0
  v_mov_b32 v30, 0
  v_mov_b32 v31, 0
  s_mov_b32 s50, 0
  s_mov_b32 s51, 0
  s_waitcnt lgkmcnt(0)
  s_barrier
  ds_read_b128 v[64:67], v112 offset:0
  ds_read_b64_tr_b16 v[68:69], v116 offset:0
  ds_read_b64_tr_b16 v[70:71], v116 offset:512
  ds_read_b64_tr_b16 v[72:73], v117 offset:0
  ds_read_b64_tr_b16 v[74:75], v117 offset:512
  ds_read_b128 v[76:79], v113 offset:0
  ds_read_b64_tr_b16 v[80:81], v116 offset:2048
  ds_read_b64_tr_b16 v[82:83], v116 offset:2560
  ds_read_b64_tr_b16 v[84:85], v117 offset:2048
  ds_read_b64_tr_b16 v[86:87], v117 offset:2560
  ds_read_b128 v[88:91], v114 offset:0
  ds_read_b64_tr_b16 v[92:93], v116 offset:4096
  ds_read_b64_tr_b16 v[94:95], v116 offset:4608
  ds_read_b64_tr_b16 v[96:97], v117 offset:4096
  ds_read_b64_tr_b16 v[98:99], v117 offset:4608
D_loop:
  s_waitcnt lgkmcnt(10)
  v_mfma_f32_32x32x16_bf16 v[0:15], v[68:71], v[64:67], v[0:15]
  ds_read_b128 v[100:103], v115 offset:0
  s_add_u32 s51, s51, 2
  ds_read_b64_tr_b16 v[104:105], v116 offset:6144
  s_cmp_eq_u32 s51, 6
  v_mfma_f32_32x32x16_bf16 v[16:31], v[72:75], v[64:67], v[16:31]
  ds_read_b64_tr_b16 v[106:107], v116 offset:6656
  s_cselect_b32 s51, 0, s51
  ds_read_b64_tr_b16 v[108:109], v117 offset:6144
  s_cselect_b32 s53, s61, s62
  ds_read_b64_tr_b16 v[110:111], v117 offset:6656
  s_waitcnt lgkmcnt(10)
  v_mfma_f32_32x32x16_bf16 v[0:15], v[80:83], v[76:79], v[0:15]
  s_cbranch_execz D_g1
  s_barrier
D_g1:
  ds_read_b128 v[64:67], v112 offset:20480
  ds_read_b64_tr_b16 v[68:69], v116 offset:20480
  v_mfma_f32_32x32x16_bf16 v[16:31], v[84:87], v[76:79], v[16:31]
  ds_read_b64_tr_b16 v[70:71], v116 offset:20992
  ds_read_b64_tr_b16 v[72:73], v117 offset:20480
  ds_read_b64_tr_b16 v[74:75], v117 offset:20992
  s_waitcnt lgkmcnt(10)
  v_mfma_f32_32x32x16_bf16 v[0:15], v[92:95], v[88:91], v[0:15]
  ds_read_b128 v[76:79], v113 offset:20480
  ds_read_b64_tr_b16 v[80:81], v116 offset:22528
  v_mfma_f32_32x32x16_bf16 v[16:31], v[96:99], v[88:91], v[16:31]
  ds_read_b64_tr_b16 v[82:83], v116 offset:23040
  ds_read_b64_tr_b16 v[84:85], v117 offset:22528
  ds_read_b64_tr_b16 v[86:87], v117 offset:23040
  s_waitcnt lgkmcnt(10)
  v_mfma_f32_32x32x16_bf16 v[0:15], v[104:107], v[100:103], v[0:15]
  ds_read_b128 v[88:91], v114 offset:20480
  ds_read_b64_tr_b16 v[92:93], v116 offset:24576
  v_mfma_f32_32x32x16_bf16 v[16:31], v[108:111], v[100:103], v[16:31]
  ds_read_b64_tr_b16 v[94:95], v116 offset:25088
  ds_read_b64_tr_b16 v[96:97], v117 offset:24576
  ds_read_b64_tr_b16 v[98:99], v117 offset:25088
  s_waitcnt lgkmcnt(10)
  v_mfma_f32_32x32x16_bf16 v[0:15], v[68:71], v[64:67], v[0:15]
  ds_read_b128 v[100:103], v115 offset:20480
  ds_read_b64_tr_b16 v[104:105], v116 offset:26624
  ds_read_b64_tr_b16 v[106:107], v116 offset:27136
  ds_read_b64_tr_b16 v[108:109], v117 offset:26624
  v_mfma_f32_32x32x16_bf16 v[16:31], v[72:75], v[64:67], v[16:31]
  ds_read_b64_tr_b16 v[110:111], v117 offset:27136
  v_add_u32 v115, s53, v115
  v_add_u32 v116, s53, v116
  v_add_u32 v117, s53, v117
  s_waitcnt lgkmcnt(10)
  v_mfma_f32_32x32x16_bf16 v[0:15], v[80:83], v[76:79], v[0:15]
  s_cbranch_execz D_g2
  s_barrier
D_g2:
  v_add_u32 v112, s53, v112
  ds_read_b128 v[64:67], v112 offset:0
  v_mfma_f32_32x32x16_bf16 v[16:31], v[84:87], v[76:79], v[16:31]
  ds_read_b64_tr_b16 v[68:69], v116 offset:0
  ds_read_b64_tr_b16 v[70:71], v116 offset:512
  ds_read_b64_tr_b16 v[72:73], v117 offset:0
  ds_read_b64_tr_b16 v[74:75], v117 offset:512
  s_waitcnt lgkmcnt(10)
  v_mfma_f32_32x32x16_bf16 v[0:15], v[92:95], v[88:91], v[0:15]
  v_add_u32 v113, s53, v113
  ds_read_b128 v[76:79], v113 offset:0
  ds_read_b64_tr_b16 v[80:81], v116 offset:2048
  v_mfma_f32_32x32x16_bf16 v[16:31], v[96:99], v[88:91], v[16:31]
  ds_read_b64_tr_b16 v[82:83], v116 offset:2560
  ds_read_b64_tr_b16 v[84:85], v117 offset:2048
  ds_read_b64_tr_b16 v[86:87], v117 offset:2560
  s_add_u32 s50, s50, 2
  s_waitcnt lgkmcnt(10)
  v_mfma_f32_32x32x16_bf16 v[0:15], v[104:107], v[100:103], v[0:15]
  v_add_u32 v114, s53, v114
  ds_read_b128 v[88:91], v114 offset:0
  ds_read_b64_tr_b16 v[92:93], v116 offset:4096
  v_mfma_f32_32x32x16_bf16 v[16:31], v[108:111], v[100:103], v[16:31]
  ds_read_b64_tr_b16 v[94:95], v116 offset:4608
  ds_read_b64_tr_b16 v[96:97], v117 offset:4096
  ds_read_b64_tr_b16 v[98:99], v117 offset:4608
  s_cmp_lt_u32 s50, 24
  s_cbranch_scc1 D_loop
  s_cbranch_execz D_real
D_q1:
  s_waitcnt lgkmcnt(0)
  ds_read_b64_tr_b16 v[140:141], v193 offset:0
  ds_read_b64_tr_b16 v[142:143], v193 offset:1024
  ds_read_b64_tr_b16 v[144:145], v193 offset:2048
  ds_read_b64_tr_b16 v[146:147], v193 offset:3072
  ds_read_b64_tr_b16 v[148:149], v193 offset:4096
  ds_read_b64_tr_b16 v[150:151], v193 offset:5120
  ds_read_b64_tr_b16 v[152:153], v193 offset:6144
  ds_read_b64_tr_b16 v[154:155], v193 offset:7168
  s_cbranch_execz D_g3
  s_waitcnt vmcnt(0)
D_g3:
  s_waitcnt lgkmcnt(6)
  v_xor_b32 v112, 0, v197
  ds_read_b128 v[156:159], v112
  ds_read_b128 v[172:175], v112 offset:4096
  v_xor_b32 v113, 16, v197
  ds_read_b128 v[160:163], v113
  ds_read_b128 v[176:179], v113 offset:4096
  v_xor_b32 v114, 32, v197
  ds_read_b128 v[164:167], v114
  ds_read_b128 v[180:183], v114 offset:4096
  v_xor_b32 v115, 48, v197
  ds_read_b128 v[168:171], v115
  ds_read_b128 v[184:187], v115 offset:4096
  v_mul_f32 v188, v188, v189
  v_sub_f32 v188, 0, v188
  s_mov_b32 s54, 0xffff0000
  v_mov_b32 v124, 0
  v_mov_b32 v125, 0
  v_mov_b32 v126, 0
  v_mov_b32 v127, 0
  s_nop 3
  s_waitcnt lgkmcnt(0)
  v_lshlrev_b32 v72, 16, v156
  v_and_b32 v73, s54, v156
  v_pk_add_f32 v[0:1], v[0:1], v[72:73]
  v_pk_fma_f32 v[72:73], v[72:73], v[188:189], v[188:189] op_sel:[0,1,0] op_sel_hi:[1,1,0]
  v_lshlrev_b32 v74, 16, v140
  v_and_b32 v75, s54, v140
  v_pk_fma_f32 v[0:1], v[72:73], v[74:75], v[0:1]
  v_lshlrev_b32 v72, 16, v172
  v_and_b32 v73, s54, v172
  v_pk_add_f32 v[0:1], v[0:1], v[72:73]
  v_cvt_pk_bf16_f32 v64, v0, v1
  v_lshlrev_b32 v72, 16, v157
  v_and_b32 v73, s54, v157
  v_pk_add_f32 v[2:3], v[2:3], v[72:73]
  v_pk_fma_f32 v[72:73], v[72:73], v[188:189], v[188:189] op_sel:[0,1,0] op_sel_hi:[1,1,0]
  v_lshlrev_b32 v74, 16, v141
  v_and_b32 v75, s54, v141
  v_pk_fma_f32 v[2:3], v[72:73], v[74:75], v[2:3]
  v_lshlrev_b32 v72, 16, v173
  v_and_b32 v73, s54, v173
  v_pk_add_f32 v[2:3], v[2:3], v[72:73]
  v_cvt_pk_bf16_f32 v65, v2, v3
  v_lshlrev_b32 v72, 16, v158
  v_and_b32 v73, s54, v158
  v_pk_add_f32 v[4:5], v[4:5], v[72:73]
  v_pk_fma_f32 v[72:73], v[72:73], v[188:189], v[188:189] op_sel:[0,1,0] op_sel_hi:[1,1,0]
  v_lshlrev_b32 v74, 16, v142
  v_and_b32 v75, s54, v142
  v_pk_fma_f32 v[4:5], v[72:73], v[74:75], v[4:5]
  v_lshlrev_b32 v72, 16, v174
  v_and_b32 v73, s54, v174
  v_pk_add_f32 v[4:5], v[4:5], v[72:73]
  v_cvt_pk_bf16_f32 v66, v4, v5
  v_lshlrev_b32 v72, 16, v159
  v_and_b32 v73, s54, v159
  v_pk_add_f32 v[6:7], v[6:7], v[72:73]
  v_pk_fma_f32 v[72:73], v[72:73], v[188:189], v[188:189] op_sel:[0,1,0] op_sel_hi:[1,1,0]
  v_lshlrev_b32 v74, 16, v143
  v_and_b32 v75, s54, v143
  v_pk_fma_f32 v[6:7], v[72:73], v[74:75], v[6:7]
  v_lshlrev_b32 v72, 16, v175
  v_and_b32 v73, s54, v175
  v_pk_add_f32 v[6:7], v[6:7], v[72:73]
  v_cvt_pk_bf16_f32 v67, v6, v7
  ds_write_b128 v112, v[64:67]
  s_cbranch_execz D_real
D_q2:
  v_lshlrev_b32 v72, 16, v160
  v_and_b32 v73, s54, v160
  v_pk_add_f32 v[8:9], v[8:9], v[72:73]
  v_pk_fma_f32 v[72:73], v[72:73], v[188:189], v[188:189] op_sel:[0,1,0] op_sel_hi:[1,1,0]
  v_lshlrev_b32 v74, 16, v144
  v_and_b32 v75, s54, v144
  v_pk_fma_f32 v[8:9], v[72:73], v[74:75], v[8:9]
  v_lshlrev_b32 v72, 16, v176
  v_and_b32 v73, s54, v176
  v_pk_add_f32 v[8:9], v[8:9], v[72:73]
  v_cvt_pk_bf16_f32 v68, v8, v9
  v_lshlrev_b32 v72, 16, v161
  v_and_b32 v73, s54, v161
  v_pk_add_f32 v[10:11], v[10:11], v[72:73]
  v_pk_fma_f32 v[72:73], v[72:73], v[188:189], v[188:189] op_sel:[0,1,0] op_sel_hi:[1,1,0]
  v_lshlrev_b32 v74, 16, v145
  v_and_b32 v75, s54, v145
  v_pk_fma_f32 v[10:11], v[72:73], v[74:75], v[10:11]
  v_lshlrev_b32 v72, 16, v177
  v_and_b32 v73, s54, v177
  v_pk_add_f32 v[10:11], v[10:11], v[72:73]
  v_cvt_pk_bf16_f32 v69, v10, v11
  v_lshlrev_b32 v72, 16, v162
  v_and_b32 v73, s54, v162
  v_pk_add_f32 v[12:13], v[12:13], v[72:73]
  v_pk_fma_f32 v[72:73], v[72:73], v[188:189], v[188:189] op_sel:[0,1,0] op_sel_hi:[1,1,0]
  v_lshlrev_b32 v74, 16, v146
  v_and_b32 v75, s54, v146
  v_pk_fma_f32 v[12:13], v[72:73], v[74:75], v[12:13]
  v_lshlrev_b32 v72, 16, v178
  v_and_b32 v73, s54, v178
  v_pk_add_f32 v[12:13], v[12:13], v[72:73]
  v_cvt_pk_bf16_f32 v70, v12, v13
  v_lshlrev_b32 v72, 16, v163
  v_and_b32 v73, s54, v163
  v_pk_add_f32 v[14:15], v[14:15], v[72:73]
  v_pk_fma_f32 v[72:73], v[72:73], v[188:189], v[188:189] op_sel:[0,1,0] op_sel_hi:[1,1,0]
  v_lshlrev_b32 v74, 16, v147
  v_and_b32 v75, s54, v147
  v_pk_fma_f32 v[14:15], v[72:73], v[74:75], v[14:15]
  v_lshlrev_b32 v72, 16, v179
  v_and_b32 v73, s54, v179
  v_pk_add_f32 v[14:15], v[14:15], v[72:73]
  v_cvt_pk_bf16_f32 v71, v14, v15
  ds_write_b128 v113, v[68:71]
  v_lshlrev_b32 v72, 16, v164
  v_and_b32 v73, s54, v164
  v_pk_add_f32 v[16:17], v[16:17], v[72:73]
  v_pk_fma_f32 v[72:73], v[72:73], v[188:189], v[188:189] op_sel:[0,1,0] op_sel_hi:[1,1,0]
  v_lshlrev_b32 v74, 16, v148
  v_and_b32 v75, s54, v148
  v_pk_fma_f32 v[16:17], v[72:73], v[74:75], v[16:17]
  v_lshlrev_b32 v72, 16, v180
  v_and_b32 v73, s54, v180
  v_pk_add_f32 v[16:17], v[16:17], v[72:73]
  v_cvt_pk_bf16_f32 v64, v16, v17
  v_lshlrev_b32 v72, 16, v165
  v_and_b32 v73, s54, v165
  v_pk_add_f32 v[18:19], v[18:19], v[72:73]
  v_pk_fma_f32 v[72:73], v[72:73], v[188:189], v[188:189] op_sel:[0,1,0] op_sel_hi:[1,1,0]
  v_lshlrev_b32 v74, 16, v149
  v_and_b32 v75, s54, v149
  v_pk_fma_f32 v[18:19], v[72:73], v[74:75], v[18:19]
  v_lshlrev_b32 v72, 16, v181
  v_and_b32 v73, s54, v181
  v_pk_add_f32 v[18:19], v[18:19], v[72:73]
  v_cvt_pk_bf16_f32 v65, v18, v19
  v_lshlrev_b32 v72, 16, v166
  v_and_b32 v73, s54, v166
  v_pk_add_f32 v[20:21], v[20:21], v[72:73]
  v_pk_fma_f32 v[72:73], v[72:73], v[188:189], v[188:189] op_sel:[0,1,0] op_sel_hi:[1,1,0]
  v_lshlrev_b32 v74, 16, v150
  v_and_b32 v75, s54, v150
  v_pk_fma_f32 v[20:21], v[72:73], v[74:75], v[20:21]
  v_lshlrev_b32 v72, 16, v182
  v_and_b32 v73, s54, v182
  v_pk_add_f32 v[20:21], v[20:21], v[72:73]
  v_cvt_pk_bf16_f32 v66, v20, v21
  v_lshlrev_b32 v72, 16, v167
  v_and_b32 v73, s54, v167
  v_pk_add_f32 v[22:23], v[22:23], v[72:73]
  v_pk_fma_f32 v[72:73], v[72:73], v[188:189], v[188:189] op_sel:[0,1,0] op_sel_hi:[1,1,0]
  v_lshlrev_b32 v74, 16, v151
  v_and_b32 v75, s54, v151
  v_pk_fma_f32 v[22:23], v[72:73], v[74:75], v[22:23]
  v_lshlrev_b32 v72, 16, v183
  v_and_b32 v73, s54, v183
  v_pk_add_f32 v[22:23], v[22:23], v[72:73]
  v_cvt_pk_bf16_f32 v67, v22, v23
  ds_write_b128 v114, v[64:67]
D_q3:
  v_lshlrev_b32 v72, 16, v168
  v_and_b32 v73, s54, v168
  v_pk_add_f32 v[24:25], v[24:25], v[72:73]
  v_pk_fma_f32 v[72:73], v[72:73], v[188:189], v[188:189] op_sel:[0,1,0] op_sel_hi:[1,1,0]
  v_lshlrev_b32 v74, 16, v152
  v_and_b32 v75, s54, v152
  v_pk_fma_f32 v[24:25], v[72:73], v[74:75], v[24:25]
  v_lshlrev_b32 v72, 16, v184
  v_and_b32 v73, s54, v184
  v_pk_add_f32 v[24:25], v[24:25], v[72:73]
  v_cvt_pk_bf16_f32 v68, v24, v25
  v_lshlrev_b32 v72, 16, v169
  v_and_b32 v73, s54, v169
  v_pk_add_f32 v[26:27], v[26:27], v[72:73]
  v_pk_fma_f32 v[72:73], v[72:73], v[188:189], v[188:189] op_sel:[0,1,0] op_sel_hi:[1,1,0]
  v_lshlrev_b32 v74, 16, v153
  v_and_b32 v75, s54, v153
  v_pk_fma_f32 v[26:27], v[72:73], v[74:75], v[26:27]
  v_lshlrev_b32 v72, 16, v185
  v_and_b32 v73, s54, v185
  v_pk_add_f32 v[26:27], v[26:27], v[72:73]
  v_cvt_pk_bf16_f32 v69, v26, v27
  v_lshlrev_b32 v72, 16, v170
  v_and_b32 v73, s54, v170
  v_pk_add_f32 v[28:29], v[28:29], v[72:73]
  v_pk_fma_f32 v[72:73], v[72:73], v[188:189], v[188:189] op_sel:[0,1,0] op_sel_hi:[1,1,0]
  v_lshlrev_b32 v74, 16, v154
  v_and_b32 v75, s54, v154
  v_pk_fma_f32 v[28:29], v[72:73], v[74:75], v[28:29]
  v_lshlrev_b32 v72, 16, v186
  v_and_b32 v73, s54, v186
  v_pk_add_f32 v[28:29], v[28:29], v[72:73]
  v_cvt_pk_bf16_f32 v70, v28, v29
  v_lshlrev_b32 v72, 16, v171
  v_and_b32 v73, s54, v171
  v_pk_add_f32 v[30:31], v[30:31], v[72:73]
  v_pk_fma_f32 v[72:73], v[72:73], v[188:189], v[188:189] op_sel:[0,1,0] op_sel_hi:[1,1,0]
  v_lshlrev_b32 v74, 16, v155
  v_and_b32 v75, s54, v155
  v_pk_fma_f32 v[30:31], v[72:73], v[74:75], v[30:31]
  v_lshlrev_b32 v72, 16, v187
  v_and_b32 v73, s54, v187
  v_pk_add_f32 v[30:31], v[30:31], v[72:73]
  v_cvt_pk_bf16_f32 v71, v30, v31
  ds_write_b128 v115, v[68:71]
  ds_read_b128 v[156:159], v198 offset:0
  ds_read_b128 v[160:163], v198 offset:1024
  ds_read_b128 v[164:167], v198 offset:2048
  ds_read_b128 v[168:171], v198 offset:3072
  s_waitcnt lgkmcnt(3)
  s_cbranch_execz D_g4
  buffer_store_dwordx4 v[156:159], v196, s[16:19], s80 offen sc0 sc1
D_g4:
  s_waitcnt lgkmcnt(2)
  s_cbranch_execz D_g5
  buffer_store_dwordx4 v[160:163], v196, s[16:19], s81 offen sc0 sc1
D_g5:
  s_waitcnt lgkmcnt(1)
  s_cbranch_execz D_g6
  buffer_store_dwordx4 v[164:167], v196, s[16:19], s82 offen sc0 sc1
D_g6:
  s_waitcnt lgkmcnt(0)
  s_cbranch_execz D_g7
  buffer_store_dwordx4 v[168:171], v196, s[16:19], s83 offen sc0 sc1
D_g7:
  s_cbranch_execz D_real
  s_waitcnt vmcnt(0) lgkmcnt(0)
  s_endpgm
D_side:
  s_sub_u32 s2, s2, 224
  s_cmp_ge_u32 s2, 32
  s_cbranch_scc1 D_end
  s_load_dwordx2 s[4:5], s[0:1], 104
  s_load_dwordx2 s[6:7], s[0:1], 80
  s_lshr_b32 s63, s2, 3
  s_lshl_b32 s63, s63, 3
  s_add_u32 s63, s63, s60
  s_waitcnt lgkmcnt(0)
  s_and_b32 s44, s2, 7
  s_mul_i32 s44, s44, 183512
  s_lshr_b32 s44, s44, 16
  s_mul_i32 s46, s44, 294912
  v_mul_u32_u24 v1, 3072, v0
  s_add_u32 s8, s4, 0xb00000
  s_addc_u32 s9, s5, 0
  s_mov_b32 s10, 0x600000
  s_mov_b32 s11, 0x00020000
D_pfl:
  s_mul_i32 s45, s63, 10923
  s_lshr_b32 s45, s45, 16
  s_mul_i32 s44, s45, 6
  s_sub_u32 s44, s63, s44
  s_mul_i32 s44, s44, 196608
  s_add_u32 s44, s44, s46
  s_lshl_b32 s45, s45, 7
  v_add_u32 v2, s44, v1
  s_add_u32 s63, s63, 32
  buffer_load_dword v3, v2, s[8:11], s45 offen sc1
  s_cmp_lt_u32 s63, 144
  s_cbranch_scc1 D_pfl
  s_waitcnt vmcnt(0) lgkmcnt(0)
  s_endpgm
D_end:
  s_waitcnt lgkmcnt(0)
  s_endpgm
T_end:
.section .rodata,"a"
.p2align 6
.amdhsa_kernel kA_kernel
  .amdhsa_next_free_vgpr 208
  .amdhsa_next_free_sgpr 96
  .amdhsa_accum_offset 208
  .amdhsa_group_segment_fixed_size 0
  .amdhsa_kernarg_size 112
  .amdhsa_user_sgpr_count 2
  .amdhsa_user_sgpr_kernarg_segment_ptr 1
  .amdhsa_system_sgpr_workgroup_id_x 1
.end_amdhsa_kernel
.p2align 6
.amdhsa_kernel kB_kernel
  .amdhsa_next_free_vgpr 200
  .amdhsa_next_free_sgpr 96
  .amdhsa_accum_offset 200
  .amdhsa_group_segment_fixed_size 0
  .amdhsa_kernarg_size 112
  .amdhsa_user_sgpr_count 2
  .amdhsa_user_sgpr_kernarg_segment_ptr 1
  .amdhsa_system_sgpr_workgroup_id_x 1
.end_amdhsa_kernel
.p2align 6
.amdhsa_kernel kC_kernel
  .amdhsa_next_free_vgpr 240
  .amdhsa_next_free_sgpr 96
  .amdhsa_accum_offset 240
  .amdhsa_group_segment_fixed_size 0
  .amdhsa_kernarg_size 112
  .amdhsa_user_sgpr_count 2
  .amdhsa_user_sgpr_kernarg_segment_ptr 1
  .amdhsa_system_sgpr_workgroup_id_x 1
.end_amdhsa_kernel
.p2align 6
.amdhsa_kernel kD_kernel
  .amdhsa_next_free_vgpr 200
  .amdhsa_next_free_sgpr 96
  .amdhsa_accum_offset 200
  .amdhsa_group_segment_fixed_size 0
  .amdhsa_kernarg_size 112
  .amdhsa_user_sgpr_count 2
  .amdhsa_user_sgpr_kernarg_segment_ptr 1
  .amdhsa_system_sgpr_workgroup_id_x 1
.end_amdhsa_kernel
```
